```python
import torch

def _softmax(x, axis=-1):
    return torch.softmax(x, dim=axis)

def _gelu(x):
    return torch.nn.functional.gelu(x, approximate='tanh')

def _silu(x):
    return torch.nn.functional.silu(x)

def _sigmoid(x):
    return torch.sigmoid(x)

def _layernorm(x, axis=-1, eps=1e-05):
    m = x.mean(dim=axis, keepdim=True)
    v = x.var(dim=axis, keepdim=True, unbiased=False)
    return (x - m) / torch.sqrt(v + eps)

def _scatter_add(tgt, idx, src, axis=0):
    return tgt.clone().index_add_(axis, idx, src)

def _segment_sum(src, seg, n):
    out = torch.zeros((n,) + src.shape[1:], dtype=src.dtype)
    return out.index_add_(0, seg, src)

def _pad(x, pw):
    flat = tuple((v for pair in reversed(pw) for v in pair))
    return torch.nn.functional.pad(x, flat)
kernel_name = 'adaLN_cond__memory_aug_recurrent_mem_tr__mixer_token_mlp__prompt'

def setup_inputs():

    _w = lambda a: (lambda t: t.to(torch.bfloat16) if t.is_floating_point() else t)(torch.as_tensor(a))

    def _A_setup():
        B, S, Dm = (1, 2048, 512)
        H, Dh = (32, 128)
        M, seg = (8, 32)
        seg = min(seg, S)
        S = S // seg * seg
        return {'x': _w((lambda *s: torch.randn(*s, dtype=torch.bfloat16) * 0.05)(B, S, Dm)), 'mem0': _w((lambda *s: torch.randn(*s, dtype=torch.bfloat16) * 0.4)(B, M, Dm)), 'Wq': _w((lambda *s: torch.randn(*s, dtype=torch.bfloat16) * 1.6)(Dm, H, Dh) * Dm ** (-0.5)), 'Wk': _w((lambda *s: torch.randn(*s, dtype=torch.bfloat16) * 1.6)(Dm, H, Dh) * Dm ** (-0.5)), 'Wv': _w((lambda *s: torch.randn(*s, dtype=torch.bfloat16) * 0.4)(Dm, H, Dh) * Dm ** (-0.5)), 'Wo': _w((lambda *s: torch.randn(*s, dtype=torch.bfloat16) * 0.4)(H, Dh, Dm) * (H * Dh) ** (-0.5)), 'seg_len': seg}
    _A_in = _A_setup()

    def _B_setup():
        B, S, D, F = (1, 2048, 512, 1792)
        return {'x': _w((lambda *s: torch.randn(*s, dtype=torch.bfloat16) * 0.05)(B, S, D)), 'w1': _w((lambda *s: torch.randn(*s, dtype=torch.bfloat16) * 0.8)(S, F) * S ** (-0.5)), 'b1': _w((lambda *s: torch.randn(*s, dtype=torch.bfloat16) * 12.8)(F) * 0.02), 'w2': _w((lambda *s: torch.randn(*s, dtype=torch.bfloat16) * 0.2)(F, S) * F ** (-0.5)), 'b2': _w((lambda *s: torch.randn(*s, dtype=torch.bfloat16) * 1.6)(S) * 0.02)}
    _B_in = _B_setup()
    return {'A_x': _A_in['x'], 'A_mem0': _A_in['mem0'], 'A_Wq': _A_in['Wq'], 'A_Wk': _A_in['Wk'], 'A_Wv': _A_in['Wv'], 'A_Wo': _A_in['Wo'], 'A_seg_len': _A_in['seg_len'], 'B_x': _B_in['x'], 'B_w1': _B_in['w1'], 'B_b1': _B_in['b1'], 'B_w2': _B_in['w2'], 'B_b2': _B_in['b2'], 'c': _w((lambda *s: torch.randn(*s, dtype=torch.bfloat16) * 0.1)(1, 512) * 8.0), 'w_mod': _w((lambda *s: torch.randn(*s, dtype=torch.bfloat16) * 0.1)(512, 6 * 512) * 512 ** (-0.5) * 8.0)}

def reference(A_x, A_mem0, A_Wq, A_Wk, A_Wv, A_Wo, A_seg_len, B_x, B_w1, B_b1, B_w2, B_b2, c, w_mod):

    def _A_ref(x, mem0, Wq, Wk, Wv, Wo, seg_len):
        B, S, Dm = x.shape
        H, Dh = (Wq.shape[1], Wq.shape[2])
        M = mem0.shape[1]
        scale = Dh ** (-0.5)
        n_seg = S // seg_len
        L = M + seg_len
        idx = torch.arange(L)
        mask = (idx[:, None] < M) | (idx[:, None] >= idx[None, :])
        mem = mem0
        outs = []
        for s in range(n_seg):
            xs = x[:, s * seg_len:(s + 1) * seg_len, :].clone()
            h = torch.concatenate([mem, xs], axis=1)
            q = torch.einsum('btd,dhe->bhte', h, Wq)
            k = torch.einsum('btd,dhe->bhte', h, Wk)
            v = torch.einsum('btd,dhe->bhte', h, Wv)
            scores = torch.einsum('bhqe,bhke->bhqk', q, k) * scale
            scores = torch.where(mask[None, None], scores, -1000000000.0)
            p = _softmax(scores, axis=-1)
            o = torch.einsum('bhqk,bhke->bhqe', p, v)
            o = torch.einsum('bhte,hed->btd', o, Wo)
            mem = o[:, :M, :].clone()
            outs.append(o[:, M:, :])
        return torch.concatenate(outs, axis=1)

    def _B_ref(x, w1, b1, w2, b2):
        B, S, D = x.shape
        h = _layernorm(x, axis=-1)
        u = torch.einsum('bsd,sf->bdf', h, w1) + b1
        u = _gelu(u)
        y = torch.einsum('bdf,fs->bds', u, w2) + b2
        return (lambda x, *d: x.permute(*d))(y, 0, 2, 1)
    x = A_x
    mod = (_silu(c) @ w_mod).reshape(c.shape[0], 6, 1, -1)
    sa, ca, ga, sb, cb, gb = (mod[:, 0].clone(), mod[:, 1].clone(), mod[:, 2].clone(), mod[:, 3].clone(), mod[:, 4].clone(), mod[:, 5].clone())
    h = _layernorm(x, axis=-1) * (1 + ca) + sa
    x = x + ga * _A_ref(h, A_mem0, A_Wq, A_Wk, A_Wv, A_Wo, A_seg_len)
    h = _layernorm(x, axis=-1) * (1 + cb) + sb
    x = x + gb * _B_ref(h, B_w1, B_b1, B_w2, B_b2)
    return x
```

```asm
; @launch grid=(256,1,1) block=(512,1,1) lds=163840
.amdgcn_target "amdgcn-amd-amdhsa--gfx950"
.text
.globl adaLN_cond__memory_aug_recurrent_mem_tr__mixer_token_mlp__prompt_kernel
.p2align 8
.type adaLN_cond__memory_aug_recurrent_mem_tr__mixer_token_mlp__prompt_kernel,@function
adaLN_cond__memory_aug_recurrent_mem_tr__mixer_token_mlp__prompt_kernel:
    s_cmp_ge_u32 s2, 256
    s_cbranch_scc1 L_end
    s_load_dwordx4 s[92:95], s[0:1], 120
    v_lshrrev_b32 v1, 6, v0
    v_and_b32 v0, 63, v0
    v_readfirstlane_b32 s91, v1
    s_getreg_b32 s20, hwreg(HW_REG_XCC_ID, 0, 4)
    s_waitcnt lgkmcnt(0)
    s_add_u32 s96, s94, 524288
    s_addc_u32 s97, s95, 0
    s_load_dwordx4 s[12:15], s[0:1], 96
    s_load_dwordx2 s[16:17], s[0:1], 0
    s_mov_b32 s90, s2
    s_waitcnt lgkmcnt(0)
    s_cmp_lg_u32 s91, 6
    s_cbranch_scc1 tc_1
    s_getpc_b64 s[86:87]
tcp_2:
    s_sub_u32 s86, s86, tcp_2-adaLN_cond__memory_aug_recurrent_mem_tr__mixer_token_mlp__prompt_kernel
    s_subb_u32 s87, s87, 0
    v_lshlrev_b32 v2, 7, v0
    s_mov_b32 s88, (L_code_end-adaLN_cond__memory_aug_recurrent_mem_tr__mixer_token_mlp__prompt_kernel+8191)/8192
tcl_3:
    v_min_u32 v3, L_code_end-adaLN_cond__memory_aug_recurrent_mem_tr__mixer_token_mlp__prompt_kernel-4, v2
    global_load_dword v4, v3, s[86:87]
    v_add_u32 v2, 8192, v2
    s_sub_u32 s88, s88, 1
    s_cmp_lg_u32 s88, 0
    s_cbranch_scc1 tcl_3
    s_waitcnt vmcnt(0)
tc_1:
    s_cmp_lg_u32 s91, 7
    s_cbranch_scc1 L_role_skip
    s_and_b32 s20, s20, 7
    v_mov_b32 v2, 0
    v_mov_b32 v3, 1
    s_mov_b64 exec, 1
    s_cmp_lg_u32 s20, 0
    s_cbranch_scc1 L_role_worker
    global_atomic_add v4, v2, v3, s[92:93] sc0 sc1
    s_waitcnt vmcnt(0)
    v_readfirstlane_b32 s22, v4
    s_nop 0
    s_cmp_lt_u32 s22, 32
    s_cbranch_scc1 L_role_done
L_role_worker:
    v_mov_b32 v2, 128
    global_atomic_add v4, v2, v3, s[92:93] sc0 sc1
    s_waitcnt vmcnt(0)
    v_readfirstlane_b32 s22, v4
    s_nop 0
    s_sub_u32 s23, 255, s22
    s_add_u32 s22, s22, 32
    s_cmp_lt_u32 s22, 256
    s_cselect_b32 s22, s22, s23
L_role_done:
    v_mov_b32 v4, s22
    v_mov_b32 v2, 163776
    ds_write_b32 v2, v4
    s_mov_b64 exec, -1
    s_waitcnt lgkmcnt(0)
L_role_skip:
    s_cmp_ge_u32 s2, 64
    s_cbranch_scc1 L_nomod
    s_and_b32 s19, s2, 7
    s_sub_u32 s19, s19, 1
    s_cmp_ge_u32 s19, 6
    s_cbranch_scc1 L_nomod
    s_lshr_b32 s18, s2, 3
    s_mul_i32 s18, s18, 6
    s_add_u32 s18, s18, s19
    v_lshlrev_b32 v2, 4, v0
    s_lshl_b32 s19, s18, 10
    v_add_u32 v2, s19, v2
    v_mov_b32 v4, 0
    v_mov_b32 v5, 0
    v_mov_b32 v6, 0
    v_mov_b32 v7, 0
    global_store_dwordx4 v2, v[4:7], s[96:97] sc1
    s_add_u32 s20, s94, 0
    s_addc_u32 s21, s95, 0
    v_lshrrev_b32 v1, 3, v0
    s_lshl_b32 s40, s91, 6
    v_add_u32 v1, s40, v1
    v_and_b32 v2, 7, v0
    v_mul_u32_u24 v3, 6144, v1
    v_lshl_add_u32 v3, v2, 4, v3
    s_lshl_b32 s40, s18, 7
    v_add_u32 v3, s40, v3
    v_lshlrev_b32 v4, 1, v1
    global_load_ushort v40, v4, s[12:13] offset:0
    global_load_ushort v41, v4, s[12:13] offset:16
    global_load_ushort v42, v4, s[12:13] offset:32
    global_load_ushort v43, v4, s[12:13] offset:48
    global_load_ushort v44, v4, s[12:13] offset:64
    global_load_ushort v45, v4, s[12:13] offset:80
    global_load_ushort v46, v4, s[12:13] offset:96
    global_load_ushort v47, v4, s[12:13] offset:112
    global_load_dwordx4 v[8:11], v3, s[14:15]
    v_add_u32 v3, 49152, v3
    global_load_dwordx4 v[12:15], v3, s[14:15]
    v_add_u32 v3, 49152, v3
    global_load_dwordx4 v[16:19], v3, s[14:15]
    v_add_u32 v3, 49152, v3
    global_load_dwordx4 v[20:23], v3, s[14:15]
    v_add_u32 v3, 49152, v3
    global_load_dwordx4 v[24:27], v3, s[14:15]
    v_add_u32 v3, 49152, v3
    global_load_dwordx4 v[28:31], v3, s[14:15]
    v_add_u32 v3, 49152, v3
    global_load_dwordx4 v[32:35], v3, s[14:15]
    v_add_u32 v3, 49152, v3
    global_load_dwordx4 v[36:39], v3, s[14:15]
    s_waitcnt vmcnt(8)
    v_lshlrev_b32 v40, 16, v40
    v_mul_f32 v4, 0xbfb8aa3b, v40
    v_exp_f32 v4, v4
    s_nop 0
    v_add_f32 v4, 1.0, v4
    v_rcp_f32 v4, v4
    s_nop 0
    v_mul_f32 v40, v40, v4
    v_cvt_pk_bf16_f32 v40, v40, v40
    v_lshlrev_b32 v40, 16, v40
    v_lshlrev_b32 v41, 16, v41
    v_mul_f32 v4, 0xbfb8aa3b, v41
    v_exp_f32 v4, v4
    s_nop 0
    v_add_f32 v4, 1.0, v4
    v_rcp_f32 v4, v4
    s_nop 0
    v_mul_f32 v41, v41, v4
    v_cvt_pk_bf16_f32 v41, v41, v41
    v_lshlrev_b32 v41, 16, v41
    v_lshlrev_b32 v42, 16, v42
    v_mul_f32 v4, 0xbfb8aa3b, v42
    v_exp_f32 v4, v4
    s_nop 0
    v_add_f32 v4, 1.0, v4
    v_rcp_f32 v4, v4
    s_nop 0
    v_mul_f32 v42, v42, v4
    v_cvt_pk_bf16_f32 v42, v42, v42
    v_lshlrev_b32 v42, 16, v42
    v_lshlrev_b32 v43, 16, v43
    v_mul_f32 v4, 0xbfb8aa3b, v43
    v_exp_f32 v4, v4
    s_nop 0
    v_add_f32 v4, 1.0, v4
    v_rcp_f32 v4, v4
    s_nop 0
    v_mul_f32 v43, v43, v4
    v_cvt_pk_bf16_f32 v43, v43, v43
    v_lshlrev_b32 v43, 16, v43
    v_lshlrev_b32 v44, 16, v44
    v_mul_f32 v4, 0xbfb8aa3b, v44
    v_exp_f32 v4, v4
    s_nop 0
    v_add_f32 v4, 1.0, v4
    v_rcp_f32 v4, v4
    s_nop 0
    v_mul_f32 v44, v44, v4
    v_cvt_pk_bf16_f32 v44, v44, v44
    v_lshlrev_b32 v44, 16, v44
    v_lshlrev_b32 v45, 16, v45
    v_mul_f32 v4, 0xbfb8aa3b, v45
    v_exp_f32 v4, v4
    s_nop 0
    v_add_f32 v4, 1.0, v4
    v_rcp_f32 v4, v4
    s_nop 0
    v_mul_f32 v45, v45, v4
    v_cvt_pk_bf16_f32 v45, v45, v45
    v_lshlrev_b32 v45, 16, v45
    v_lshlrev_b32 v46, 16, v46
    v_mul_f32 v4, 0xbfb8aa3b, v46
    v_exp_f32 v4, v4
    s_nop 0
    v_add_f32 v4, 1.0, v4
    v_rcp_f32 v4, v4
    s_nop 0
    v_mul_f32 v46, v46, v4
    v_cvt_pk_bf16_f32 v46, v46, v46
    v_lshlrev_b32 v46, 16, v46
    v_lshlrev_b32 v47, 16, v47
    v_mul_f32 v4, 0xbfb8aa3b, v47
    v_exp_f32 v4, v4
    s_nop 0
    v_add_f32 v4, 1.0, v4
    v_rcp_f32 v4, v4
    s_nop 0
    v_mul_f32 v47, v47, v4
    v_cvt_pk_bf16_f32 v47, v47, v47
    v_lshlrev_b32 v47, 16, v47
    v_mov_b32 v48, 0
    v_mov_b32 v49, 0
    v_mov_b32 v50, 0
    v_mov_b32 v51, 0
    v_mov_b32 v52, 0
    v_mov_b32 v53, 0
    v_mov_b32 v54, 0
    v_mov_b32 v55, 0
    s_waitcnt vmcnt(7)
    v_lshlrev_b32 v4, 16, v8
    v_fmac_f32 v48, v4, v40
    v_and_b32 v4, 0xffff0000, v8
    v_fmac_f32 v49, v4, v40
    v_lshlrev_b32 v4, 16, v9
    v_fmac_f32 v50, v4, v40
    v_and_b32 v4, 0xffff0000, v9
    v_fmac_f32 v51, v4, v40
    v_lshlrev_b32 v4, 16, v10
    v_fmac_f32 v52, v4, v40
    v_and_b32 v4, 0xffff0000, v10
    v_fmac_f32 v53, v4, v40
    v_lshlrev_b32 v4, 16, v11
    v_fmac_f32 v54, v4, v40
    v_and_b32 v4, 0xffff0000, v11
    v_fmac_f32 v55, v4, v40
    s_waitcnt vmcnt(6)
    v_lshlrev_b32 v4, 16, v12
    v_fmac_f32 v48, v4, v41
    v_and_b32 v4, 0xffff0000, v12
    v_fmac_f32 v49, v4, v41
    v_lshlrev_b32 v4, 16, v13
    v_fmac_f32 v50, v4, v41
    v_and_b32 v4, 0xffff0000, v13
    v_fmac_f32 v51, v4, v41
    v_lshlrev_b32 v4, 16, v14
    v_fmac_f32 v52, v4, v41
    v_and_b32 v4, 0xffff0000, v14
    v_fmac_f32 v53, v4, v41
    v_lshlrev_b32 v4, 16, v15
    v_fmac_f32 v54, v4, v41
    v_and_b32 v4, 0xffff0000, v15
    v_fmac_f32 v55, v4, v41
    s_waitcnt vmcnt(5)
    v_lshlrev_b32 v4, 16, v16
    v_fmac_f32 v48, v4, v42
    v_and_b32 v4, 0xffff0000, v16
    v_fmac_f32 v49, v4, v42
    v_lshlrev_b32 v4, 16, v17
    v_fmac_f32 v50, v4, v42
    v_and_b32 v4, 0xffff0000, v17
    v_fmac_f32 v51, v4, v42
    v_lshlrev_b32 v4, 16, v18
    v_fmac_f32 v52, v4, v42
    v_and_b32 v4, 0xffff0000, v18
    v_fmac_f32 v53, v4, v42
    v_lshlrev_b32 v4, 16, v19
    v_fmac_f32 v54, v4, v42
    v_and_b32 v4, 0xffff0000, v19
    v_fmac_f32 v55, v4, v42
    s_waitcnt vmcnt(4)
    v_lshlrev_b32 v4, 16, v20
    v_fmac_f32 v48, v4, v43
    v_and_b32 v4, 0xffff0000, v20
    v_fmac_f32 v49, v4, v43
    v_lshlrev_b32 v4, 16, v21
    v_fmac_f32 v50, v4, v43
    v_and_b32 v4, 0xffff0000, v21
    v_fmac_f32 v51, v4, v43
    v_lshlrev_b32 v4, 16, v22
    v_fmac_f32 v52, v4, v43
    v_and_b32 v4, 0xffff0000, v22
    v_fmac_f32 v53, v4, v43
    v_lshlrev_b32 v4, 16, v23
    v_fmac_f32 v54, v4, v43
    v_and_b32 v4, 0xffff0000, v23
    v_fmac_f32 v55, v4, v43
    s_waitcnt vmcnt(3)
    v_lshlrev_b32 v4, 16, v24
    v_fmac_f32 v48, v4, v44
    v_and_b32 v4, 0xffff0000, v24
    v_fmac_f32 v49, v4, v44
    v_lshlrev_b32 v4, 16, v25
    v_fmac_f32 v50, v4, v44
    v_and_b32 v4, 0xffff0000, v25
    v_fmac_f32 v51, v4, v44
    v_lshlrev_b32 v4, 16, v26
    v_fmac_f32 v52, v4, v44
    v_and_b32 v4, 0xffff0000, v26
    v_fmac_f32 v53, v4, v44
    v_lshlrev_b32 v4, 16, v27
    v_fmac_f32 v54, v4, v44
    v_and_b32 v4, 0xffff0000, v27
    v_fmac_f32 v55, v4, v44
    s_waitcnt vmcnt(2)
    v_lshlrev_b32 v4, 16, v28
    v_fmac_f32 v48, v4, v45
    v_and_b32 v4, 0xffff0000, v28
    v_fmac_f32 v49, v4, v45
    v_lshlrev_b32 v4, 16, v29
    v_fmac_f32 v50, v4, v45
    v_and_b32 v4, 0xffff0000, v29
    v_fmac_f32 v51, v4, v45
    v_lshlrev_b32 v4, 16, v30
    v_fmac_f32 v52, v4, v45
    v_and_b32 v4, 0xffff0000, v30
    v_fmac_f32 v53, v4, v45
    v_lshlrev_b32 v4, 16, v31
    v_fmac_f32 v54, v4, v45
    v_and_b32 v4, 0xffff0000, v31
    v_fmac_f32 v55, v4, v45
    s_waitcnt vmcnt(1)
    v_lshlrev_b32 v4, 16, v32
    v_fmac_f32 v48, v4, v46
    v_and_b32 v4, 0xffff0000, v32
    v_fmac_f32 v49, v4, v46
    v_lshlrev_b32 v4, 16, v33
    v_fmac_f32 v50, v4, v46
    v_and_b32 v4, 0xffff0000, v33
    v_fmac_f32 v51, v4, v46
    v_lshlrev_b32 v4, 16, v34
    v_fmac_f32 v52, v4, v46
    v_and_b32 v4, 0xffff0000, v34
    v_fmac_f32 v53, v4, v46
    v_lshlrev_b32 v4, 16, v35
    v_fmac_f32 v54, v4, v46
    v_and_b32 v4, 0xffff0000, v35
    v_fmac_f32 v55, v4, v46
    s_waitcnt vmcnt(0)
    v_lshlrev_b32 v4, 16, v36
    v_fmac_f32 v48, v4, v47
    v_and_b32 v4, 0xffff0000, v36
    v_fmac_f32 v49, v4, v47
    v_lshlrev_b32 v4, 16, v37
    v_fmac_f32 v50, v4, v47
    v_and_b32 v4, 0xffff0000, v37
    v_fmac_f32 v51, v4, v47
    v_lshlrev_b32 v4, 16, v38
    v_fmac_f32 v52, v4, v47
    v_and_b32 v4, 0xffff0000, v38
    v_fmac_f32 v53, v4, v47
    v_lshlrev_b32 v4, 16, v39
    v_fmac_f32 v54, v4, v47
    v_and_b32 v4, 0xffff0000, v39
    v_fmac_f32 v55, v4, v47
    v_add_f32_dpp v48, v48, v48 row_ror:8 row_mask:0xf bank_mask:0xf
    v_mov_b32 v4, v48
    s_nop 1
    v_permlane16_swap_b32 v48, v4
    v_add_f32 v48, v48, v4
    v_mov_b32 v4, v48
    s_nop 1
    v_permlane32_swap_b32 v48, v4
    v_add_f32 v48, v48, v4
    v_add_f32_dpp v49, v49, v49 row_ror:8 row_mask:0xf bank_mask:0xf
    v_mov_b32 v4, v49
    s_nop 1
    v_permlane16_swap_b32 v49, v4
    v_add_f32 v49, v49, v4
    v_mov_b32 v4, v49
    s_nop 1
    v_permlane32_swap_b32 v49, v4
    v_add_f32 v49, v49, v4
    v_add_f32_dpp v50, v50, v50 row_ror:8 row_mask:0xf bank_mask:0xf
    v_mov_b32 v4, v50
    s_nop 1
    v_permlane16_swap_b32 v50, v4
    v_add_f32 v50, v50, v4
    v_mov_b32 v4, v50
    s_nop 1
    v_permlane32_swap_b32 v50, v4
    v_add_f32 v50, v50, v4
    v_add_f32_dpp v51, v51, v51 row_ror:8 row_mask:0xf bank_mask:0xf
    v_mov_b32 v4, v51
    s_nop 1
    v_permlane16_swap_b32 v51, v4
    v_add_f32 v51, v51, v4
    v_mov_b32 v4, v51
    s_nop 1
    v_permlane32_swap_b32 v51, v4
    v_add_f32 v51, v51, v4
    v_add_f32_dpp v52, v52, v52 row_ror:8 row_mask:0xf bank_mask:0xf
    v_mov_b32 v4, v52
    s_nop 1
    v_permlane16_swap_b32 v52, v4
    v_add_f32 v52, v52, v4
    v_mov_b32 v4, v52
    s_nop 1
    v_permlane32_swap_b32 v52, v4
    v_add_f32 v52, v52, v4
    v_add_f32_dpp v53, v53, v53 row_ror:8 row_mask:0xf bank_mask:0xf
    v_mov_b32 v4, v53
    s_nop 1
    v_permlane16_swap_b32 v53, v4
    v_add_f32 v53, v53, v4
    v_mov_b32 v4, v53
    s_nop 1
    v_permlane32_swap_b32 v53, v4
    v_add_f32 v53, v53, v4
    v_add_f32_dpp v54, v54, v54 row_ror:8 row_mask:0xf bank_mask:0xf
    v_mov_b32 v4, v54
    s_nop 1
    v_permlane16_swap_b32 v54, v4
    v_add_f32 v54, v54, v4
    v_mov_b32 v4, v54
    s_nop 1
    v_permlane32_swap_b32 v54, v4
    v_add_f32 v54, v54, v4
    v_add_f32_dpp v55, v55, v55 row_ror:8 row_mask:0xf bank_mask:0xf
    v_mov_b32 v4, v55
    s_nop 1
    v_permlane16_swap_b32 v55, v4
    v_add_f32 v55, v55, v4
    v_mov_b32 v4, v55
    s_nop 1
    v_permlane32_swap_b32 v55, v4
    v_add_f32 v55, v55, v4
    s_lshl_b32 s40, s91, 8
    v_lshlrev_b32 v4, 5, v2
    v_add_u32 v4, s40, v4
    ds_write_b128 v4, v[48:51] offset:16384
    ds_write_b128 v4, v[52:55] offset:16400
    s_waitcnt lgkmcnt(0)
    s_barrier
    s_cmp_lg_u32 s91, 0
    s_cbranch_scc1 mod_skip_4
    v_lshlrev_b32 v4, 2, v0
    ds_read_b32 v8, v4 offset:16384
    ds_read_b32 v9, v4 offset:16640
    ds_read_b32 v10, v4 offset:16896
    ds_read_b32 v11, v4 offset:17152
    ds_read_b32 v12, v4 offset:17408
    ds_read_b32 v13, v4 offset:17664
    ds_read_b32 v14, v4 offset:17920
    ds_read_b32 v15, v4 offset:18176
    s_waitcnt lgkmcnt(0)
    v_add_f32 v8, v8, v9
    v_add_f32 v8, v8, v10
    v_add_f32 v8, v8, v11
    v_add_f32 v8, v8, v12
    v_add_f32 v8, v8, v13
    v_add_f32 v8, v8, v14
    v_add_f32 v8, v8, v15
    v_cvt_pk_bf16_f32 v8, v8, v8
    v_lshlrev_b32 v8, 16, v8
    s_lshl_b32 s40, s18, 8
    v_add_u32 v4, s40, v4
    global_store_dword v4, v8, s[20:21] sc1
mod_skip_4:
    s_waitcnt vmcnt(0)
    s_barrier
    s_cmp_lg_u32 s91, 0
    s_cbranch_scc1 wgs_5
    v_mov_b32 v10, 44
    v_mov_b32 v11, 1
    s_mov_b64 exec, 1
    global_atomic_add v10, v11, s[92:93] sc1
    s_mov_b64 exec, -1
wgs_5:
L_nomod:
    s_barrier
    v_mov_b32 v2, 163776
    ds_read_b32 v4, v2
    s_waitcnt lgkmcnt(0)
    v_readfirstlane_b32 s90, v4
    s_nop 3
    s_cmp_ge_u32 s90, 256
    s_cbranch_scc1 L_end
    s_cmp_lt_u32 s90, 32
    s_cbranch_scc1 L_head
    s_sub_u32 s90, s90, 32
    s_add_u32 s20, s94, 0
    s_addc_u32 s21, s95, 0
    s_add_u32 s22, s94, 1048576
    s_addc_u32 s23, s95, 0
    s_load_dwordx4 s[4:7], s[0:1], 16
    s_load_dwordx2 s[8:9], s[0:1], 32
    s_mov_b32 s18, s90
    v_and_b32 v105, 7, v0
    v_bfe_u32 v106, v0, 4, 1
    v_lshlrev_b32 v106, 2, v106
    v_xor_b32 v105, v105, v106
    v_lshrrev_b32 v106, 3, v0
    v_lshlrev_b32 v106, 13, v106
    v_lshl_add_u32 v100, v105, 4, v106
    v_lshrrev_b32 v105, 5, v0
    v_bfe_u32 v106, v0, 2, 2
    v_lshl_add_u32 v105, v105, 3, v106
    v_lshlrev_b32 v105, 7, v105
    v_bfe_u32 v106, v0, 3, 1
    v_lshl_add_u32 v105, v106, 6, v105
    v_bfe_u32 v106, v0, 4, 1
    v_lshl_add_u32 v105, v106, 5, v105
    v_and_b32 v106, 3, v0
    v_lshl_add_u32 v101, v106, 3, v105
    v_xor_b32 v102, 64, v101
    v_and_b32 v105, 15, v0
    v_lshlrev_b32 v105, 4, v105
    v_lshrrev_b32 v106, 5, v0
    v_lshl_add_u32 v105, v106, 8, v105
    v_bfe_u32 v106, v0, 4, 1
    v_lshl_add_u32 v103, v106, 12, v105
    v_lshl_add_u32 v104, v106, 10, v105
    s_mov_b32 s44, 0
    v_add_u32 v101, 32768, v101
    v_add_u32 v102, 32768, v102
    s_mov_b32 s44, 32768
L_ln_loop:
    s_lshl_b32 s40, s18, 3
    s_add_u32 s40, s40, s91
    s_lshl_b32 s40, s40, 10
    v_lshlrev_b32 v64, 4, v0
    v_add_u32 v61, s40, v64
    global_load_dwordx4 v[68:71], v61, s[16:17]
    s_waitcnt lgkmcnt(0)
    s_cmp_ge_u32 s90, 192
    s_cbranch_scc1 L_now
    s_cmp_lt_u32 s90, 64
    s_cselect_b32 s40, s6, s8
    s_cselect_b32 s41, s7, s9
    s_cmp_lt_u32 s90, 128
    s_cselect_b32 s40, s40, s4
    s_cselect_b32 s41, s41, s5
    s_and_b32 s46, s90, 63
    s_lshl_b32 s46, s46, 7
    s_lshl_b32 s47, s91, 19
    s_add_u32 s46, s46, s47
    s_add_u32 s40, s40, s46
    s_addc_u32 s41, s41, 0
    s_lshl_b32 s46, s91, 13
    s_add_u32 s46, s46, s44
    s_add_u32 m0, s46, 0
    s_nop 0
    global_load_lds_dwordx4 v100, s[40:41]
    s_add_u32 s40, s40, 65536
    s_addc_u32 s41, s41, 0
    s_add_u32 m0, s46, 1024
    s_nop 0
    global_load_lds_dwordx4 v100, s[40:41]
    s_add_u32 s40, s40, 65536
    s_addc_u32 s41, s41, 0
    s_add_u32 m0, s46, 2048
    s_nop 0
    global_load_lds_dwordx4 v100, s[40:41]
    s_add_u32 s40, s40, 65536
    s_addc_u32 s41, s41, 0
    s_add_u32 m0, s46, 3072
    s_nop 0
    global_load_lds_dwordx4 v100, s[40:41]
    s_add_u32 s40, s40, 65536
    s_addc_u32 s41, s41, 0
    s_add_u32 m0, s46, 4096
    s_nop 0
    global_load_lds_dwordx4 v100, s[40:41]
    s_add_u32 s40, s40, 65536
    s_addc_u32 s41, s41, 0
    s_add_u32 m0, s46, 5120
    s_nop 0
    global_load_lds_dwordx4 v100, s[40:41]
    s_add_u32 s40, s40, 65536
    s_addc_u32 s41, s41, 0
    s_add_u32 m0, s46, 6144
    s_nop 0
    global_load_lds_dwordx4 v100, s[40:41]
    s_add_u32 s40, s40, 65536
    s_addc_u32 s41, s41, 0
    s_add_u32 m0, s46, 7168
    s_nop 0
    global_load_lds_dwordx4 v100, s[40:41]
    s_xor_b32 s44, s44, 0x10000
    s_waitcnt vmcnt(8)
    s_branch L_now2
L_now:
    s_waitcnt vmcnt(0)
L_now2:
    v_lshlrev_b32 v72, 16, v68
    v_and_b32 v73, 0xffff0000, v68
    v_lshlrev_b32 v74, 16, v69
    v_and_b32 v75, 0xffff0000, v69
    v_lshlrev_b32 v76, 16, v70
    v_and_b32 v77, 0xffff0000, v70
    v_lshlrev_b32 v78, 16, v71
    v_and_b32 v79, 0xffff0000, v71
    v_add_f32 v62, v72, v73
    v_add_f32 v64, v74, v75
    v_add_f32 v63, v76, v77
    v_add_f32 v62, v62, v64
    v_add_f32 v64, v78, v79
    v_add_f32 v63, v63, v64
    v_add_f32 v62, v62, v63
    s_nop 1
    v_add_f32_dpp v62, v62, v62 quad_perm:[1,0,3,2] row_mask:0xf bank_mask:0xf
    s_nop 1
    v_add_f32_dpp v62, v62, v62 quad_perm:[2,3,0,1] row_mask:0xf bank_mask:0xf
    s_nop 1
    v_add_f32_dpp v62, v62, v62 row_ror:4 row_mask:0xf bank_mask:0xf
    s_nop 1
    v_add_f32_dpp v62, v62, v62 row_ror:8 row_mask:0xf bank_mask:0xf
    v_mov_b32 v64, v62
    s_nop 1
    v_permlane16_swap_b32 v62, v64
    v_add_f32 v62, v62, v64
    v_mov_b32 v64, v62
    s_nop 1
    v_permlane32_swap_b32 v62, v64
    v_add_f32 v62, v62, v64
    v_mul_f32 v62, 0x3b000000, v62
    v_sub_f32 v72, v72, v62
    v_sub_f32 v73, v73, v62
    v_sub_f32 v74, v74, v62
    v_sub_f32 v75, v75, v62
    v_sub_f32 v76, v76, v62
    v_sub_f32 v77, v77, v62
    v_sub_f32 v78, v78, v62
    v_sub_f32 v79, v79, v62
    v_mul_f32 v63, v72, v72
    v_fmac_f32 v63, v73, v73
    v_fmac_f32 v63, v74, v74
    v_fmac_f32 v63, v75, v75
    v_fmac_f32 v63, v76, v76
    v_fmac_f32 v63, v77, v77
    v_fmac_f32 v63, v78, v78
    v_fmac_f32 v63, v79, v79
    s_nop 1
    v_add_f32_dpp v63, v63, v63 quad_perm:[1,0,3,2] row_mask:0xf bank_mask:0xf
    s_nop 1
    v_add_f32_dpp v63, v63, v63 quad_perm:[2,3,0,1] row_mask:0xf bank_mask:0xf
    s_nop 1
    v_add_f32_dpp v63, v63, v63 row_ror:4 row_mask:0xf bank_mask:0xf
    s_nop 1
    v_add_f32_dpp v63, v63, v63 row_ror:8 row_mask:0xf bank_mask:0xf
    v_mov_b32 v64, v63
    s_nop 1
    v_permlane16_swap_b32 v63, v64
    v_add_f32 v63, v63, v64
    v_mov_b32 v64, v63
    s_nop 1
    v_permlane32_swap_b32 v63, v64
    v_add_f32 v63, v63, v64
    v_mov_b32 v64, 0x3727c5ac
    v_fmac_f32 v64, 0x3b000000, v63
    v_rsq_f32 v63, v64
    s_nop 0
    v_mul_f32 v72, v72, v63
    v_mul_f32 v73, v73, v63
    v_mul_f32 v74, v74, v63
    v_mul_f32 v75, v75, v63
    v_mul_f32 v76, v76, v63
    v_mul_f32 v77, v77, v63
    v_mul_f32 v78, v78, v63
    v_mul_f32 v79, v79, v63
    s_cmp_lg_u32 s91, 0
    s_cbranch_scc1 wgw_6
    v_mov_b32 v44, 44
    s_mov_b32 s98, 8000
wp_7:
    global_load_dword v45, v44, s[92:93] sc1
    s_waitcnt vmcnt(0)
    v_cmp_le_u32 vcc, 48, v45
    s_cbranch_vccnz wpok_8
    s_sleep 1
    s_sub_u32 s98, s98, 1
    s_cbranch_scc0 wp_7
    s_branch L_err
wpok_8:
wgw_6:
    s_barrier
    v_lshlrev_b32 v64, 5, v0
    global_load_dwordx4 v[80:83], v64, s[20:21] sc1
    global_load_dwordx4 v[84:87], v64, s[20:21] offset:16 sc1
    global_load_dwordx4 v[88:91], v64, s[20:21] offset:2048 sc1
    global_load_dwordx4 v[92:95], v64, s[20:21] offset:2064 sc1
    s_waitcnt vmcnt(0)
    v_add_f32 v88, 1.0, v88
    v_fma_f32 v72, v72, v88, v80
    v_add_f32 v89, 1.0, v89
    v_fma_f32 v73, v73, v89, v81
    v_add_f32 v90, 1.0, v90
    v_fma_f32 v74, v74, v90, v82
    v_add_f32 v91, 1.0, v91
    v_fma_f32 v75, v75, v91, v83
    v_add_f32 v92, 1.0, v92
    v_fma_f32 v76, v76, v92, v84
    v_add_f32 v93, 1.0, v93
    v_fma_f32 v77, v77, v93, v85
    v_add_f32 v94, 1.0, v94
    v_fma_f32 v78, v78, v94, v86
    v_add_f32 v95, 1.0, v95
    v_fma_f32 v79, v79, v95, v87
    v_cvt_pk_bf16_f32 v68, v72, v73
    v_cvt_pk_bf16_f32 v69, v74, v75
    v_cvt_pk_bf16_f32 v70, v76, v77
    v_cvt_pk_bf16_f32 v71, v78, v79
    s_mul_i32 s40, s91, 1040
    v_lshlrev_b32 v64, 4, v0
    v_add_u32 v64, s40, v64
    ds_write_b128 v64, v[68:71]
    v_and_b32 v64, 7, v0
    v_mul_u32_u24 v62, 1040, v64
    v_lshrrev_b32 v63, 3, v0
    s_lshl_b32 s40, s91, 3
    v_add_u32 v63, s40, v63
    v_lshl_add_u32 v62, v63, 4, v62
    s_waitcnt lgkmcnt(0)
    s_barrier
    ds_read_b128 v[68:71], v62
    v_lshlrev_b32 v63, 9, v63
    v_lshl_add_u32 v63, v64, 4, v63
    s_lshr_b32 s40, s18, 2
    s_lshl_b32 s40, s40, 15
    s_and_b32 s41, s18, 3
    s_lshl_b32 s41, s41, 7
    s_add_u32 s40, s40, s41
    v_add_u32 v63, s40, v63
    s_waitcnt lgkmcnt(0)
    global_store_dwordx4 v63, v[68:71], s[22:23] sc1
    s_lshr_b32 s40, s18, 2
    s_lshl_b32 s40, s40, 6
    s_add_u32 s40, s40, 28672
    s_waitcnt vmcnt(0)
    v_mov_b32 v44, s40
    v_mov_b32 v45, 1
    s_mov_b64 exec, 1
    global_atomic_add v44, v45, s[96:97] sc1
    s_mov_b64 exec, -1
    s_add_u32 s18, s18, 32
    s_cmp_lt_u32 s18, 224
    s_cbranch_scc1 L_ln_done
    s_cmp_lt_u32 s18, 256
    s_cbranch_scc1 L_ln_loop
L_ln_done:
    s_cmp_lt_u32 s90, 192
    s_cbranch_scc1 L_qkv_go
    s_load_dwordx2 s[4:5], s[0:1], 64
    s_load_dwordx2 s[6:7], s[0:1], 80
    s_sub_u32 s40, s90, 192
    s_lshl_b32 s40, s40, 3
    s_add_u32 s40, s40, s91
    s_mul_i32 s40, s40, 28672
    v_lshlrev_b32 v2, 6, v0
    v_add_u32 v2, s40, v2
    s_waitcnt lgkmcnt(0)
    global_load_dword v3, v2, s[4:5]
    global_load_dword v4, v2, s[6:7]
    v_add_u32 v2, 4096, v2
    global_load_dword v3, v2, s[4:5]
    global_load_dword v4, v2, s[6:7]
    v_add_u32 v2, 4096, v2
    global_load_dword v3, v2, s[4:5]
    global_load_dword v4, v2, s[6:7]
    v_add_u32 v2, 4096, v2
    global_load_dword v3, v2, s[4:5]
    global_load_dword v4, v2, s[6:7]
    v_add_u32 v2, 4096, v2
    global_load_dword v3, v2, s[4:5]
    global_load_dword v4, v2, s[6:7]
    v_add_u32 v2, 4096, v2
    global_load_dword v3, v2, s[4:5]
    global_load_dword v4, v2, s[6:7]
    v_add_u32 v2, 4096, v2
    global_load_dword v3, v2, s[4:5]
    global_load_dword v4, v2, s[6:7]
    s_branch L_qkv_done
L_qkv_go:
    s_barrier
    v_lshlrev_b32 v110, 4, v0
    v_add_u32 v111, 4096, v110
    v_add_u32 v112, 8192, v110
    v_add_u32 v113, 12288, v110
    v_add_u32 v114, 16384, v110
    v_add_u32 v115, 20480, v110
    v_add_u32 v116, 24576, v110
    v_add_u32 v117, 28672, v110
    s_lshl_b32 s40, s91, 15
    s_add_u32 s40, s40, 1048576
    s_add_u32 s24, s94, s40
    s_addc_u32 s25, s95, 0
    s_lshl_b32 s40, s91, 6
    s_add_u32 s26, s40, 28672
    v_mov_b32 v108, s26
    s_mov_b32 s98, 8000
wp_9:
    global_load_dword v109, v108, s[96:97] sc1
    s_waitcnt vmcnt(0)
    v_cmp_le_u32 vcc, 32, v109
    s_cbranch_vccnz wpok_10
    s_sleep 2
    s_sub_u32 s98, s98, 1
    s_cbranch_scc0 wp_9
    s_branch L_err
wpok_10:
    global_load_dwordx4 a[0:3], v110, s[24:25] offset:0 sc1
    global_load_dwordx4 a[4:7], v110, s[24:25] offset:1024 sc1
    global_load_dwordx4 a[8:11], v110, s[24:25] offset:2048 sc1
    global_load_dwordx4 a[12:15], v110, s[24:25] offset:3072 sc1
    global_load_dwordx4 a[16:19], v111, s[24:25] offset:0 sc1
    global_load_dwordx4 a[20:23], v111, s[24:25] offset:1024 sc1
    global_load_dwordx4 a[24:27], v111, s[24:25] offset:2048 sc1
    global_load_dwordx4 a[28:31], v111, s[24:25] offset:3072 sc1
    global_load_dwordx4 a[32:35], v112, s[24:25] offset:0 sc1
    global_load_dwordx4 a[36:39], v112, s[24:25] offset:1024 sc1
    global_load_dwordx4 a[40:43], v112, s[24:25] offset:2048 sc1
    global_load_dwordx4 a[44:47], v112, s[24:25] offset:3072 sc1
    global_load_dwordx4 a[48:51], v113, s[24:25] offset:0 sc1
    global_load_dwordx4 a[52:55], v113, s[24:25] offset:1024 sc1
    global_load_dwordx4 a[56:59], v113, s[24:25] offset:2048 sc1
    global_load_dwordx4 a[60:63], v113, s[24:25] offset:3072 sc1
    global_load_dwordx4 a[64:67], v114, s[24:25] offset:0 sc1
    global_load_dwordx4 a[68:71], v114, s[24:25] offset:1024 sc1
    global_load_dwordx4 a[72:75], v114, s[24:25] offset:2048 sc1
    global_load_dwordx4 a[76:79], v114, s[24:25] offset:3072 sc1
    global_load_dwordx4 a[80:83], v115, s[24:25] offset:0 sc1
    global_load_dwordx4 a[84:87], v115, s[24:25] offset:1024 sc1
    global_load_dwordx4 a[88:91], v115, s[24:25] offset:2048 sc1
    global_load_dwordx4 a[92:95], v115, s[24:25] offset:3072 sc1
    global_load_dwordx4 a[96:99], v116, s[24:25] offset:0 sc1
    global_load_dwordx4 a[100:103], v116, s[24:25] offset:1024 sc1
    global_load_dwordx4 a[104:107], v116, s[24:25] offset:2048 sc1
    global_load_dwordx4 a[108:111], v116, s[24:25] offset:3072 sc1
    global_load_dwordx4 a[112:115], v117, s[24:25] offset:0 sc1
    global_load_dwordx4 a[116:119], v117, s[24:25] offset:1024 sc1
    global_load_dwordx4 a[120:123], v117, s[24:25] offset:2048 sc1
    global_load_dwordx4 a[124:127], v117, s[24:25] offset:3072 sc1
    s_mov_b32 s18, 0
    s_cmp_lt_u32 s90, 128
    s_cselect_b32 s27, 1, 0x100
    s_bfe_u32 s28, s90, 0x50001
    s_lshl_b32 s28, s28, 2
    s_lshl_b32 s40, s91, 7
    s_add_u32 s28, s28, s40
    s_sub_u32 s40, s90, 64
    s_cmp_lt_u32 s40, 64
    s_cbranch_scc1 L_qkv_loop_v
L_qkv_loop_k:
    s_add_u32 s24, s24, 262144
    s_addc_u32 s25, s25, 0
    s_add_u32 s26, s26, 512
    s_cmp_eq_u32 s18, 7
    s_cbranch_scc1 nopoll_11
    v_mov_b32 v108, s26
    s_mov_b32 s98, 8000
wp_12:
    global_load_dword v109, v108, s[96:97] sc1
    s_waitcnt vmcnt(0)
    v_cmp_le_u32 vcc, 32, v109
    s_cbranch_vccnz wpok_13
    s_sleep 2
    s_sub_u32 s98, s98, 1
    s_cbranch_scc0 wp_12
    s_branch L_err
wpok_13:
nopoll_11:
    s_waitcnt vmcnt(0)
    s_cmp_eq_u32 s18, 7
    s_cselect_b32 s40, 262144, 0
    s_sub_u32 s24, s24, s40
    s_subb_u32 s25, s25, 0
    ds_read_b64_tr_b16 v[16:17], v101 offset:0
    ds_read_b64_tr_b16 v[18:19], v101 offset:512
    ds_read_b64_tr_b16 v[20:21], v102 offset:0
    ds_read_b64_tr_b16 v[22:23], v102 offset:512
    ds_read_b64_tr_b16 v[24:25], v101 offset:2048
    ds_read_b64_tr_b16 v[26:27], v101 offset:2560
    ds_read_b64_tr_b16 v[28:29], v102 offset:2048
    ds_read_b64_tr_b16 v[30:31], v102 offset:2560
    ds_read_b64_tr_b16 v[32:33], v101 offset:4096
    ds_read_b64_tr_b16 v[34:35], v101 offset:4608
    ds_read_b64_tr_b16 v[36:37], v102 offset:4096
    ds_read_b64_tr_b16 v[38:39], v102 offset:4608
    ds_read_b64_tr_b16 v[40:41], v101 offset:6144
    ds_read_b64_tr_b16 v[42:43], v101 offset:6656
    ds_read_b64_tr_b16 v[44:45], v102 offset:6144
    ds_read_b64_tr_b16 v[46:47], v102 offset:6656
    s_waitcnt lgkmcnt(12)
    v_mfma_f32_32x32x16_bf16 v[48:63], v[16:19], a[0:3], 0
    v_mfma_f32_32x32x16_bf16 v[64:79], v[20:23], a[0:3], 0
    ds_read_b64_tr_b16 v[16:17], v101 offset:8192
    ds_read_b64_tr_b16 v[18:19], v101 offset:8704
    ds_read_b64_tr_b16 v[20:21], v102 offset:8192
    ds_read_b64_tr_b16 v[22:23], v102 offset:8704
    s_waitcnt lgkmcnt(12)
    v_mfma_f32_32x32x16_bf16 v[48:63], v[24:27], a[4:7], v[48:63]
    v_mfma_f32_32x32x16_bf16 v[64:79], v[28:31], a[4:7], v[64:79]
    global_load_dwordx4 a[0:3], v110, s[24:25] offset:0 sc1
    ds_read_b64_tr_b16 v[24:25], v101 offset:10240
    ds_read_b64_tr_b16 v[26:27], v101 offset:10752
    ds_read_b64_tr_b16 v[28:29], v102 offset:10240
    ds_read_b64_tr_b16 v[30:31], v102 offset:10752
    s_waitcnt lgkmcnt(12)
    v_mfma_f32_32x32x16_bf16 v[48:63], v[32:35], a[8:11], v[48:63]
    v_mfma_f32_32x32x16_bf16 v[64:79], v[36:39], a[8:11], v[64:79]
    global_load_dwordx4 a[4:7], v110, s[24:25] offset:1024 sc1
    ds_read_b64_tr_b16 v[32:33], v101 offset:12288
    ds_read_b64_tr_b16 v[34:35], v101 offset:12800
    ds_read_b64_tr_b16 v[36:37], v102 offset:12288
    ds_read_b64_tr_b16 v[38:39], v102 offset:12800
    s_waitcnt lgkmcnt(12)
    v_mfma_f32_32x32x16_bf16 v[48:63], v[40:43], a[12:15], v[48:63]
    v_mfma_f32_32x32x16_bf16 v[64:79], v[44:47], a[12:15], v[64:79]
    global_load_dwordx4 a[8:11], v110, s[24:25] offset:2048 sc1
    ds_read_b64_tr_b16 v[40:41], v101 offset:14336
    ds_read_b64_tr_b16 v[42:43], v101 offset:14848
    ds_read_b64_tr_b16 v[44:45], v102 offset:14336
    ds_read_b64_tr_b16 v[46:47], v102 offset:14848
    s_waitcnt lgkmcnt(12)
    v_mfma_f32_32x32x16_bf16 v[48:63], v[16:19], a[16:19], v[48:63]
    v_mfma_f32_32x32x16_bf16 v[64:79], v[20:23], a[16:19], v[64:79]
    global_load_dwordx4 a[12:15], v110, s[24:25] offset:3072 sc1
    ds_read_b64_tr_b16 v[16:17], v101 offset:16384
    ds_read_b64_tr_b16 v[18:19], v101 offset:16896
    ds_read_b64_tr_b16 v[20:21], v102 offset:16384
    ds_read_b64_tr_b16 v[22:23], v102 offset:16896
    s_waitcnt lgkmcnt(12)
    v_mfma_f32_32x32x16_bf16 v[48:63], v[24:27], a[20:23], v[48:63]
    v_mfma_f32_32x32x16_bf16 v[64:79], v[28:31], a[20:23], v[64:79]
    global_load_dwordx4 a[16:19], v111, s[24:25] offset:0 sc1
    ds_read_b64_tr_b16 v[24:25], v101 offset:18432
    ds_read_b64_tr_b16 v[26:27], v101 offset:18944
    ds_read_b64_tr_b16 v[28:29], v102 offset:18432
    ds_read_b64_tr_b16 v[30:31], v102 offset:18944
    s_waitcnt lgkmcnt(12)
    v_mfma_f32_32x32x16_bf16 v[48:63], v[32:35], a[24:27], v[48:63]
    v_mfma_f32_32x32x16_bf16 v[64:79], v[36:39], a[24:27], v[64:79]
    global_load_dwordx4 a[20:23], v111, s[24:25] offset:1024 sc1
    ds_read_b64_tr_b16 v[32:33], v101 offset:20480
    ds_read_b64_tr_b16 v[34:35], v101 offset:20992
    ds_read_b64_tr_b16 v[36:37], v102 offset:20480
    ds_read_b64_tr_b16 v[38:39], v102 offset:20992
    s_waitcnt lgkmcnt(12)
    v_mfma_f32_32x32x16_bf16 v[48:63], v[40:43], a[28:31], v[48:63]
    v_mfma_f32_32x32x16_bf16 v[64:79], v[44:47], a[28:31], v[64:79]
    global_load_dwordx4 a[24:27], v111, s[24:25] offset:2048 sc1
    ds_read_b64_tr_b16 v[40:41], v101 offset:22528
    ds_read_b64_tr_b16 v[42:43], v101 offset:23040
    ds_read_b64_tr_b16 v[44:45], v102 offset:22528
    ds_read_b64_tr_b16 v[46:47], v102 offset:23040
    s_waitcnt lgkmcnt(12)
    v_mfma_f32_32x32x16_bf16 v[48:63], v[16:19], a[32:35], v[48:63]
    v_mfma_f32_32x32x16_bf16 v[64:79], v[20:23], a[32:35], v[64:79]
    global_load_dwordx4 a[28:31], v111, s[24:25] offset:3072 sc1
    ds_read_b64_tr_b16 v[16:17], v101 offset:24576
    ds_read_b64_tr_b16 v[18:19], v101 offset:25088
    ds_read_b64_tr_b16 v[20:21], v102 offset:24576
    ds_read_b64_tr_b16 v[22:23], v102 offset:25088
    s_waitcnt lgkmcnt(12)
    v_mfma_f32_32x32x16_bf16 v[48:63], v[24:27], a[36:39], v[48:63]
    v_mfma_f32_32x32x16_bf16 v[64:79], v[28:31], a[36:39], v[64:79]
    global_load_dwordx4 a[32:35], v112, s[24:25] offset:0 sc1
    ds_read_b64_tr_b16 v[24:25], v101 offset:26624
    ds_read_b64_tr_b16 v[26:27], v101 offset:27136
    ds_read_b64_tr_b16 v[28:29], v102 offset:26624
    ds_read_b64_tr_b16 v[30:31], v102 offset:27136
    s_waitcnt lgkmcnt(12)
    v_mfma_f32_32x32x16_bf16 v[48:63], v[32:35], a[40:43], v[48:63]
    v_mfma_f32_32x32x16_bf16 v[64:79], v[36:39], a[40:43], v[64:79]
    global_load_dwordx4 a[36:39], v112, s[24:25] offset:1024 sc1
    ds_read_b64_tr_b16 v[32:33], v101 offset:28672
    ds_read_b64_tr_b16 v[34:35], v101 offset:29184
    ds_read_b64_tr_b16 v[36:37], v102 offset:28672
    ds_read_b64_tr_b16 v[38:39], v102 offset:29184
    s_waitcnt lgkmcnt(12)
    v_mfma_f32_32x32x16_bf16 v[48:63], v[40:43], a[44:47], v[48:63]
    v_mfma_f32_32x32x16_bf16 v[64:79], v[44:47], a[44:47], v[64:79]
    global_load_dwordx4 a[40:43], v112, s[24:25] offset:2048 sc1
    ds_read_b64_tr_b16 v[40:41], v101 offset:30720
    ds_read_b64_tr_b16 v[42:43], v101 offset:31232
    ds_read_b64_tr_b16 v[44:45], v102 offset:30720
    ds_read_b64_tr_b16 v[46:47], v102 offset:31232
    s_waitcnt lgkmcnt(12)
    v_mfma_f32_32x32x16_bf16 v[48:63], v[16:19], a[48:51], v[48:63]
    v_mfma_f32_32x32x16_bf16 v[64:79], v[20:23], a[48:51], v[64:79]
    global_load_dwordx4 a[44:47], v112, s[24:25] offset:3072 sc1
    ds_read_b64_tr_b16 v[16:17], v101 offset:32768
    ds_read_b64_tr_b16 v[18:19], v101 offset:33280
    ds_read_b64_tr_b16 v[20:21], v102 offset:32768
    ds_read_b64_tr_b16 v[22:23], v102 offset:33280
    s_waitcnt lgkmcnt(12)
    v_mfma_f32_32x32x16_bf16 v[48:63], v[24:27], a[52:55], v[48:63]
    v_mfma_f32_32x32x16_bf16 v[64:79], v[28:31], a[52:55], v[64:79]
    global_load_dwordx4 a[48:51], v113, s[24:25] offset:0 sc1
    ds_read_b64_tr_b16 v[24:25], v101 offset:34816
    ds_read_b64_tr_b16 v[26:27], v101 offset:35328
    ds_read_b64_tr_b16 v[28:29], v102 offset:34816
    ds_read_b64_tr_b16 v[30:31], v102 offset:35328
    s_waitcnt lgkmcnt(12)
    v_mfma_f32_32x32x16_bf16 v[48:63], v[32:35], a[56:59], v[48:63]
    v_mfma_f32_32x32x16_bf16 v[64:79], v[36:39], a[56:59], v[64:79]
    global_load_dwordx4 a[52:55], v113, s[24:25] offset:1024 sc1
    ds_read_b64_tr_b16 v[32:33], v101 offset:36864
    ds_read_b64_tr_b16 v[34:35], v101 offset:37376
    ds_read_b64_tr_b16 v[36:37], v102 offset:36864
    ds_read_b64_tr_b16 v[38:39], v102 offset:37376
    s_waitcnt lgkmcnt(12)
    v_mfma_f32_32x32x16_bf16 v[48:63], v[40:43], a[60:63], v[48:63]
    v_mfma_f32_32x32x16_bf16 v[64:79], v[44:47], a[60:63], v[64:79]
    global_load_dwordx4 a[56:59], v113, s[24:25] offset:2048 sc1
    ds_read_b64_tr_b16 v[40:41], v101 offset:38912
    ds_read_b64_tr_b16 v[42:43], v101 offset:39424
    ds_read_b64_tr_b16 v[44:45], v102 offset:38912
    ds_read_b64_tr_b16 v[46:47], v102 offset:39424
    s_waitcnt lgkmcnt(12)
    v_mfma_f32_32x32x16_bf16 v[48:63], v[16:19], a[64:67], v[48:63]
    v_mfma_f32_32x32x16_bf16 v[64:79], v[20:23], a[64:67], v[64:79]
    global_load_dwordx4 a[60:63], v113, s[24:25] offset:3072 sc1
    ds_read_b64_tr_b16 v[16:17], v101 offset:40960
    ds_read_b64_tr_b16 v[18:19], v101 offset:41472
    ds_read_b64_tr_b16 v[20:21], v102 offset:40960
    ds_read_b64_tr_b16 v[22:23], v102 offset:41472
    s_waitcnt lgkmcnt(12)
    v_mfma_f32_32x32x16_bf16 v[48:63], v[24:27], a[68:71], v[48:63]
    v_mfma_f32_32x32x16_bf16 v[64:79], v[28:31], a[68:71], v[64:79]
    global_load_dwordx4 a[64:67], v114, s[24:25] offset:0 sc1
    ds_read_b64_tr_b16 v[24:25], v101 offset:43008
    ds_read_b64_tr_b16 v[26:27], v101 offset:43520
    ds_read_b64_tr_b16 v[28:29], v102 offset:43008
    ds_read_b64_tr_b16 v[30:31], v102 offset:43520
    s_waitcnt lgkmcnt(12)
    v_mfma_f32_32x32x16_bf16 v[48:63], v[32:35], a[72:75], v[48:63]
    v_mfma_f32_32x32x16_bf16 v[64:79], v[36:39], a[72:75], v[64:79]
    global_load_dwordx4 a[68:71], v114, s[24:25] offset:1024 sc1
    ds_read_b64_tr_b16 v[32:33], v101 offset:45056
    ds_read_b64_tr_b16 v[34:35], v101 offset:45568
    ds_read_b64_tr_b16 v[36:37], v102 offset:45056
    ds_read_b64_tr_b16 v[38:39], v102 offset:45568
    s_waitcnt lgkmcnt(12)
    v_mfma_f32_32x32x16_bf16 v[48:63], v[40:43], a[76:79], v[48:63]
    v_mfma_f32_32x32x16_bf16 v[64:79], v[44:47], a[76:79], v[64:79]
    global_load_dwordx4 a[72:75], v114, s[24:25] offset:2048 sc1
    ds_read_b64_tr_b16 v[40:41], v101 offset:47104
    ds_read_b64_tr_b16 v[42:43], v101 offset:47616
    ds_read_b64_tr_b16 v[44:45], v102 offset:47104
    ds_read_b64_tr_b16 v[46:47], v102 offset:47616
    s_waitcnt lgkmcnt(12)
    v_mfma_f32_32x32x16_bf16 v[48:63], v[16:19], a[80:83], v[48:63]
    v_mfma_f32_32x32x16_bf16 v[64:79], v[20:23], a[80:83], v[64:79]
    global_load_dwordx4 a[76:79], v114, s[24:25] offset:3072 sc1
    ds_read_b64_tr_b16 v[16:17], v101 offset:49152
    ds_read_b64_tr_b16 v[18:19], v101 offset:49664
    ds_read_b64_tr_b16 v[20:21], v102 offset:49152
    ds_read_b64_tr_b16 v[22:23], v102 offset:49664
    s_waitcnt lgkmcnt(12)
    v_mfma_f32_32x32x16_bf16 v[48:63], v[24:27], a[84:87], v[48:63]
    v_mfma_f32_32x32x16_bf16 v[64:79], v[28:31], a[84:87], v[64:79]
    global_load_dwordx4 a[80:83], v115, s[24:25] offset:0 sc1
    ds_read_b64_tr_b16 v[24:25], v101 offset:51200
    ds_read_b64_tr_b16 v[26:27], v101 offset:51712
    ds_read_b64_tr_b16 v[28:29], v102 offset:51200
    ds_read_b64_tr_b16 v[30:31], v102 offset:51712
    s_waitcnt lgkmcnt(12)
    v_mfma_f32_32x32x16_bf16 v[48:63], v[32:35], a[88:91], v[48:63]
    v_mfma_f32_32x32x16_bf16 v[64:79], v[36:39], a[88:91], v[64:79]
    global_load_dwordx4 a[84:87], v115, s[24:25] offset:1024 sc1
    ds_read_b64_tr_b16 v[32:33], v101 offset:53248
    ds_read_b64_tr_b16 v[34:35], v101 offset:53760
    ds_read_b64_tr_b16 v[36:37], v102 offset:53248
    ds_read_b64_tr_b16 v[38:39], v102 offset:53760
    s_waitcnt lgkmcnt(12)
    v_mfma_f32_32x32x16_bf16 v[48:63], v[40:43], a[92:95], v[48:63]
    v_mfma_f32_32x32x16_bf16 v[64:79], v[44:47], a[92:95], v[64:79]
    global_load_dwordx4 a[88:91], v115, s[24:25] offset:2048 sc1
    ds_read_b64_tr_b16 v[40:41], v101 offset:55296
    ds_read_b64_tr_b16 v[42:43], v101 offset:55808
    ds_read_b64_tr_b16 v[44:45], v102 offset:55296
    ds_read_b64_tr_b16 v[46:47], v102 offset:55808
    s_waitcnt lgkmcnt(12)
    v_mfma_f32_32x32x16_bf16 v[48:63], v[16:19], a[96:99], v[48:63]
    v_mfma_f32_32x32x16_bf16 v[64:79], v[20:23], a[96:99], v[64:79]
    global_load_dwordx4 a[92:95], v115, s[24:25] offset:3072 sc1
    ds_read_b64_tr_b16 v[16:17], v101 offset:57344
    ds_read_b64_tr_b16 v[18:19], v101 offset:57856
    ds_read_b64_tr_b16 v[20:21], v102 offset:57344
    ds_read_b64_tr_b16 v[22:23], v102 offset:57856
    s_waitcnt lgkmcnt(12)
    v_mfma_f32_32x32x16_bf16 v[48:63], v[24:27], a[100:103], v[48:63]
    v_mfma_f32_32x32x16_bf16 v[64:79], v[28:31], a[100:103], v[64:79]
    global_load_dwordx4 a[96:99], v116, s[24:25] offset:0 sc1
    ds_read_b64_tr_b16 v[24:25], v101 offset:59392
    ds_read_b64_tr_b16 v[26:27], v101 offset:59904
    ds_read_b64_tr_b16 v[28:29], v102 offset:59392
    ds_read_b64_tr_b16 v[30:31], v102 offset:59904
    s_waitcnt lgkmcnt(12)
    v_mfma_f32_32x32x16_bf16 v[48:63], v[32:35], a[104:107], v[48:63]
    v_mfma_f32_32x32x16_bf16 v[64:79], v[36:39], a[104:107], v[64:79]
    global_load_dwordx4 a[100:103], v116, s[24:25] offset:1024 sc1
    ds_read_b64_tr_b16 v[32:33], v101 offset:61440
    ds_read_b64_tr_b16 v[34:35], v101 offset:61952
    ds_read_b64_tr_b16 v[36:37], v102 offset:61440
    ds_read_b64_tr_b16 v[38:39], v102 offset:61952
    s_waitcnt lgkmcnt(12)
    v_mfma_f32_32x32x16_bf16 v[48:63], v[40:43], a[108:111], v[48:63]
    v_mfma_f32_32x32x16_bf16 v[64:79], v[44:47], a[108:111], v[64:79]
    global_load_dwordx4 a[104:107], v116, s[24:25] offset:2048 sc1
    ds_read_b64_tr_b16 v[40:41], v101 offset:63488
    ds_read_b64_tr_b16 v[42:43], v101 offset:64000
    ds_read_b64_tr_b16 v[44:45], v102 offset:63488
    ds_read_b64_tr_b16 v[46:47], v102 offset:64000
    s_waitcnt lgkmcnt(12)
    v_mfma_f32_32x32x16_bf16 v[48:63], v[16:19], a[112:115], v[48:63]
    v_mfma_f32_32x32x16_bf16 v[64:79], v[20:23], a[112:115], v[64:79]
    global_load_dwordx4 a[108:111], v116, s[24:25] offset:3072 sc1
    s_waitcnt lgkmcnt(8)
    v_mfma_f32_32x32x16_bf16 v[48:63], v[24:27], a[116:119], v[48:63]
    v_mfma_f32_32x32x16_bf16 v[64:79], v[28:31], a[116:119], v[64:79]
    global_load_dwordx4 a[112:115], v117, s[24:25] offset:0 sc1
    s_waitcnt lgkmcnt(4)
    v_mfma_f32_32x32x16_bf16 v[48:63], v[32:35], a[120:123], v[48:63]
    v_mfma_f32_32x32x16_bf16 v[64:79], v[36:39], a[120:123], v[64:79]
    global_load_dwordx4 a[116:119], v117, s[24:25] offset:1024 sc1
    s_waitcnt lgkmcnt(0)
    v_mfma_f32_32x32x16_bf16 v[48:63], v[40:43], a[124:127], v[48:63]
    v_mfma_f32_32x32x16_bf16 v[64:79], v[44:47], a[124:127], v[64:79]
    global_load_dwordx4 a[120:123], v117, s[24:25] offset:2048 sc1
    s_lshl_b32 s46, s18, 3
    s_add_u32 s46, s46, s91
    s_lshl_b32 s46, s46, 5
    s_bfe_u32 s47, s90, 0x50001
    s_add_u32 s46, s46, s47
    s_lshl_b32 s46, s46, 13
    s_and_b32 s47, s90, 1
    s_lshl_b32 s47, s47, 11
    s_add_u32 s46, s46, s47
    s_cmp_lt_u32 s90, 64
    s_cselect_b32 s47, 16777216, 0
    s_add_u32 s46, s46, s47
    s_add_u32 s46, s46, 16777216
    s_add_u32 s42, s94, s46
    s_addc_u32 s43, s95, 0
    global_load_dwordx4 a[124:127], v117, s[24:25] offset:3072 sc1
    v_cvt_pk_bf16_f32 v80, v48, v56
    v_cvt_pk_bf16_f32 v81, v49, v57
    v_cvt_pk_bf16_f32 v82, v50, v58
    v_cvt_pk_bf16_f32 v83, v51, v59
    global_store_dwordx4 v103, v[80:83], s[42:43] offset:0 sc1
    v_cvt_pk_bf16_f32 v84, v52, v60
    v_cvt_pk_bf16_f32 v85, v53, v61
    v_cvt_pk_bf16_f32 v86, v54, v62
    v_cvt_pk_bf16_f32 v87, v55, v63
    global_store_dwordx4 v103, v[84:87], s[42:43] offset:512 sc1
    v_cvt_pk_bf16_f32 v88, v64, v72
    v_cvt_pk_bf16_f32 v89, v65, v73
    v_cvt_pk_bf16_f32 v90, v66, v74
    v_cvt_pk_bf16_f32 v91, v67, v75
    global_store_dwordx4 v103, v[88:91], s[42:43] offset:1024 sc1
    v_cvt_pk_bf16_f32 v92, v68, v76
    v_cvt_pk_bf16_f32 v93, v69, v77
    v_cvt_pk_bf16_f32 v94, v70, v78
    v_cvt_pk_bf16_f32 v95, v71, v79
    global_store_dwordx4 v103, v[92:95], s[42:43] offset:1536 sc1
    s_waitcnt vmcnt(0)
    v_mov_b32 v108, s28
    v_mov_b32 v109, s27
    s_mov_b64 exec, 1
    global_atomic_add v108, v109, s[96:97] sc1
    s_mov_b64 exec, -1
    s_add_u32 s28, s28, 1024
    s_add_u32 s18, s18, 1
    s_cmp_lt_u32 s18, 8
    s_cbranch_scc1 L_qkv_loop_k
    s_branch L_qkv_done
L_qkv_loop_v:
    s_add_u32 s24, s24, 262144
    s_addc_u32 s25, s25, 0
    s_add_u32 s26, s26, 512
    s_cmp_eq_u32 s18, 7
    s_cbranch_scc1 nopoll_14
    v_mov_b32 v108, s26
    s_mov_b32 s98, 8000
wp_15:
    global_load_dword v109, v108, s[96:97] sc1
    s_waitcnt vmcnt(0)
    v_cmp_le_u32 vcc, 32, v109
    s_cbranch_vccnz wpok_16
    s_sleep 2
    s_sub_u32 s98, s98, 1
    s_cbranch_scc0 wp_15
    s_branch L_err
wpok_16:
nopoll_14:
    s_waitcnt vmcnt(0)
    s_cmp_eq_u32 s18, 7
    s_cselect_b32 s40, 262144, 0
    s_sub_u32 s24, s24, s40
    s_subb_u32 s25, s25, 0
    ds_read_b64_tr_b16 v[16:17], v101 offset:0
    ds_read_b64_tr_b16 v[18:19], v101 offset:512
    ds_read_b64_tr_b16 v[20:21], v102 offset:0
    ds_read_b64_tr_b16 v[22:23], v102 offset:512
    ds_read_b64_tr_b16 v[24:25], v101 offset:2048
    ds_read_b64_tr_b16 v[26:27], v101 offset:2560
    ds_read_b64_tr_b16 v[28:29], v102 offset:2048
    ds_read_b64_tr_b16 v[30:31], v102 offset:2560
    ds_read_b64_tr_b16 v[32:33], v101 offset:4096
    ds_read_b64_tr_b16 v[34:35], v101 offset:4608
    ds_read_b64_tr_b16 v[36:37], v102 offset:4096
    ds_read_b64_tr_b16 v[38:39], v102 offset:4608
    ds_read_b64_tr_b16 v[40:41], v101 offset:6144
    ds_read_b64_tr_b16 v[42:43], v101 offset:6656
    ds_read_b64_tr_b16 v[44:45], v102 offset:6144
    ds_read_b64_tr_b16 v[46:47], v102 offset:6656
    s_waitcnt lgkmcnt(12)
    v_mfma_f32_32x32x16_bf16 v[48:63], a[0:3], v[16:19], 0
    v_mfma_f32_32x32x16_bf16 v[64:79], a[0:3], v[20:23], 0
    ds_read_b64_tr_b16 v[16:17], v101 offset:8192
    ds_read_b64_tr_b16 v[18:19], v101 offset:8704
    ds_read_b64_tr_b16 v[20:21], v102 offset:8192
    ds_read_b64_tr_b16 v[22:23], v102 offset:8704
    s_waitcnt lgkmcnt(12)
    v_mfma_f32_32x32x16_bf16 v[48:63], a[4:7], v[24:27], v[48:63]
    v_mfma_f32_32x32x16_bf16 v[64:79], a[4:7], v[28:31], v[64:79]
    global_load_dwordx4 a[0:3], v110, s[24:25] offset:0 sc1
    ds_read_b64_tr_b16 v[24:25], v101 offset:10240
    ds_read_b64_tr_b16 v[26:27], v101 offset:10752
    ds_read_b64_tr_b16 v[28:29], v102 offset:10240
    ds_read_b64_tr_b16 v[30:31], v102 offset:10752
    s_waitcnt lgkmcnt(12)
    v_mfma_f32_32x32x16_bf16 v[48:63], a[8:11], v[32:35], v[48:63]
    v_mfma_f32_32x32x16_bf16 v[64:79], a[8:11], v[36:39], v[64:79]
    global_load_dwordx4 a[4:7], v110, s[24:25] offset:1024 sc1
    ds_read_b64_tr_b16 v[32:33], v101 offset:12288
    ds_read_b64_tr_b16 v[34:35], v101 offset:12800
    ds_read_b64_tr_b16 v[36:37], v102 offset:12288
    ds_read_b64_tr_b16 v[38:39], v102 offset:12800
    s_waitcnt lgkmcnt(12)
    v_mfma_f32_32x32x16_bf16 v[48:63], a[12:15], v[40:43], v[48:63]
    v_mfma_f32_32x32x16_bf16 v[64:79], a[12:15], v[44:47], v[64:79]
    global_load_dwordx4 a[8:11], v110, s[24:25] offset:2048 sc1
    ds_read_b64_tr_b16 v[40:41], v101 offset:14336
    ds_read_b64_tr_b16 v[42:43], v101 offset:14848
    ds_read_b64_tr_b16 v[44:45], v102 offset:14336
    ds_read_b64_tr_b16 v[46:47], v102 offset:14848
    s_waitcnt lgkmcnt(12)
    v_mfma_f32_32x32x16_bf16 v[48:63], a[16:19], v[16:19], v[48:63]
    v_mfma_f32_32x32x16_bf16 v[64:79], a[16:19], v[20:23], v[64:79]
    global_load_dwordx4 a[12:15], v110, s[24:25] offset:3072 sc1
    ds_read_b64_tr_b16 v[16:17], v101 offset:16384
    ds_read_b64_tr_b16 v[18:19], v101 offset:16896
    ds_read_b64_tr_b16 v[20:21], v102 offset:16384
    ds_read_b64_tr_b16 v[22:23], v102 offset:16896
    s_waitcnt lgkmcnt(12)
    v_mfma_f32_32x32x16_bf16 v[48:63], a[20:23], v[24:27], v[48:63]
    v_mfma_f32_32x32x16_bf16 v[64:79], a[20:23], v[28:31], v[64:79]
    global_load_dwordx4 a[16:19], v111, s[24:25] offset:0 sc1
    ds_read_b64_tr_b16 v[24:25], v101 offset:18432
    ds_read_b64_tr_b16 v[26:27], v101 offset:18944
    ds_read_b64_tr_b16 v[28:29], v102 offset:18432
    ds_read_b64_tr_b16 v[30:31], v102 offset:18944
    s_waitcnt lgkmcnt(12)
    v_mfma_f32_32x32x16_bf16 v[48:63], a[24:27], v[32:35], v[48:63]
    v_mfma_f32_32x32x16_bf16 v[64:79], a[24:27], v[36:39], v[64:79]
    global_load_dwordx4 a[20:23], v111, s[24:25] offset:1024 sc1
    ds_read_b64_tr_b16 v[32:33], v101 offset:20480
    ds_read_b64_tr_b16 v[34:35], v101 offset:20992
    ds_read_b64_tr_b16 v[36:37], v102 offset:20480
    ds_read_b64_tr_b16 v[38:39], v102 offset:20992
    s_waitcnt lgkmcnt(12)
    v_mfma_f32_32x32x16_bf16 v[48:63], a[28:31], v[40:43], v[48:63]
    v_mfma_f32_32x32x16_bf16 v[64:79], a[28:31], v[44:47], v[64:79]
    global_load_dwordx4 a[24:27], v111, s[24:25] offset:2048 sc1
    ds_read_b64_tr_b16 v[40:41], v101 offset:22528
    ds_read_b64_tr_b16 v[42:43], v101 offset:23040
    ds_read_b64_tr_b16 v[44:45], v102 offset:22528
    ds_read_b64_tr_b16 v[46:47], v102 offset:23040
    s_waitcnt lgkmcnt(12)
    v_mfma_f32_32x32x16_bf16 v[48:63], a[32:35], v[16:19], v[48:63]
    v_mfma_f32_32x32x16_bf16 v[64:79], a[32:35], v[20:23], v[64:79]
    global_load_dwordx4 a[28:31], v111, s[24:25] offset:3072 sc1
    ds_read_b64_tr_b16 v[16:17], v101 offset:24576
    ds_read_b64_tr_b16 v[18:19], v101 offset:25088
    ds_read_b64_tr_b16 v[20:21], v102 offset:24576
    ds_read_b64_tr_b16 v[22:23], v102 offset:25088
    s_waitcnt lgkmcnt(12)
    v_mfma_f32_32x32x16_bf16 v[48:63], a[36:39], v[24:27], v[48:63]
    v_mfma_f32_32x32x16_bf16 v[64:79], a[36:39], v[28:31], v[64:79]
    global_load_dwordx4 a[32:35], v112, s[24:25] offset:0 sc1
    ds_read_b64_tr_b16 v[24:25], v101 offset:26624
    ds_read_b64_tr_b16 v[26:27], v101 offset:27136
    ds_read_b64_tr_b16 v[28:29], v102 offset:26624
    ds_read_b64_tr_b16 v[30:31], v102 offset:27136
    s_waitcnt lgkmcnt(12)
    v_mfma_f32_32x32x16_bf16 v[48:63], a[40:43], v[32:35], v[48:63]
    v_mfma_f32_32x32x16_bf16 v[64:79], a[40:43], v[36:39], v[64:79]
    global_load_dwordx4 a[36:39], v112, s[24:25] offset:1024 sc1
    ds_read_b64_tr_b16 v[32:33], v101 offset:28672
    ds_read_b64_tr_b16 v[34:35], v101 offset:29184
    ds_read_b64_tr_b16 v[36:37], v102 offset:28672
    ds_read_b64_tr_b16 v[38:39], v102 offset:29184
    s_waitcnt lgkmcnt(12)
    v_mfma_f32_32x32x16_bf16 v[48:63], a[44:47], v[40:43], v[48:63]
    v_mfma_f32_32x32x16_bf16 v[64:79], a[44:47], v[44:47], v[64:79]
    global_load_dwordx4 a[40:43], v112, s[24:25] offset:2048 sc1
    ds_read_b64_tr_b16 v[40:41], v101 offset:30720
    ds_read_b64_tr_b16 v[42:43], v101 offset:31232
    ds_read_b64_tr_b16 v[44:45], v102 offset:30720
    ds_read_b64_tr_b16 v[46:47], v102 offset:31232
    s_waitcnt lgkmcnt(12)
    v_mfma_f32_32x32x16_bf16 v[48:63], a[48:51], v[16:19], v[48:63]
    v_mfma_f32_32x32x16_bf16 v[64:79], a[48:51], v[20:23], v[64:79]
    global_load_dwordx4 a[44:47], v112, s[24:25] offset:3072 sc1
    ds_read_b64_tr_b16 v[16:17], v101 offset:32768
    ds_read_b64_tr_b16 v[18:19], v101 offset:33280
    ds_read_b64_tr_b16 v[20:21], v102 offset:32768
    ds_read_b64_tr_b16 v[22:23], v102 offset:33280
    s_waitcnt lgkmcnt(12)
    v_mfma_f32_32x32x16_bf16 v[48:63], a[52:55], v[24:27], v[48:63]
    v_mfma_f32_32x32x16_bf16 v[64:79], a[52:55], v[28:31], v[64:79]
    global_load_dwordx4 a[48:51], v113, s[24:25] offset:0 sc1
    ds_read_b64_tr_b16 v[24:25], v101 offset:34816
    ds_read_b64_tr_b16 v[26:27], v101 offset:35328
    ds_read_b64_tr_b16 v[28:29], v102 offset:34816
    ds_read_b64_tr_b16 v[30:31], v102 offset:35328
    s_waitcnt lgkmcnt(12)
    v_mfma_f32_32x32x16_bf16 v[48:63], a[56:59], v[32:35], v[48:63]
    v_mfma_f32_32x32x16_bf16 v[64:79], a[56:59], v[36:39], v[64:79]
    global_load_dwordx4 a[52:55], v113, s[24:25] offset:1024 sc1
    ds_read_b64_tr_b16 v[32:33], v101 offset:36864
    ds_read_b64_tr_b16 v[34:35], v101 offset:37376
    ds_read_b64_tr_b16 v[36:37], v102 offset:36864
    ds_read_b64_tr_b16 v[38:39], v102 offset:37376
    s_waitcnt lgkmcnt(12)
    v_mfma_f32_32x32x16_bf16 v[48:63], a[60:63], v[40:43], v[48:63]
    v_mfma_f32_32x32x16_bf16 v[64:79], a[60:63], v[44:47], v[64:79]
    global_load_dwordx4 a[56:59], v113, s[24:25] offset:2048 sc1
    ds_read_b64_tr_b16 v[40:41], v101 offset:38912
    ds_read_b64_tr_b16 v[42:43], v101 offset:39424
    ds_read_b64_tr_b16 v[44:45], v102 offset:38912
    ds_read_b64_tr_b16 v[46:47], v102 offset:39424
    s_waitcnt lgkmcnt(12)
    v_mfma_f32_32x32x16_bf16 v[48:63], a[64:67], v[16:19], v[48:63]
    v_mfma_f32_32x32x16_bf16 v[64:79], a[64:67], v[20:23], v[64:79]
    global_load_dwordx4 a[60:63], v113, s[24:25] offset:3072 sc1
    ds_read_b64_tr_b16 v[16:17], v101 offset:40960
    ds_read_b64_tr_b16 v[18:19], v101 offset:41472
    ds_read_b64_tr_b16 v[20:21], v102 offset:40960
    ds_read_b64_tr_b16 v[22:23], v102 offset:41472
    s_waitcnt lgkmcnt(12)
    v_mfma_f32_32x32x16_bf16 v[48:63], a[68:71], v[24:27], v[48:63]
    v_mfma_f32_32x32x16_bf16 v[64:79], a[68:71], v[28:31], v[64:79]
    global_load_dwordx4 a[64:67], v114, s[24:25] offset:0 sc1
    ds_read_b64_tr_b16 v[24:25], v101 offset:43008
    ds_read_b64_tr_b16 v[26:27], v101 offset:43520
    ds_read_b64_tr_b16 v[28:29], v102 offset:43008
    ds_read_b64_tr_b16 v[30:31], v102 offset:43520
    s_waitcnt lgkmcnt(12)
    v_mfma_f32_32x32x16_bf16 v[48:63], a[72:75], v[32:35], v[48:63]
    v_mfma_f32_32x32x16_bf16 v[64:79], a[72:75], v[36:39], v[64:79]
    global_load_dwordx4 a[68:71], v114, s[24:25] offset:1024 sc1
    ds_read_b64_tr_b16 v[32:33], v101 offset:45056
    ds_read_b64_tr_b16 v[34:35], v101 offset:45568
    ds_read_b64_tr_b16 v[36:37], v102 offset:45056
    ds_read_b64_tr_b16 v[38:39], v102 offset:45568
    s_waitcnt lgkmcnt(12)
    v_mfma_f32_32x32x16_bf16 v[48:63], a[76:79], v[40:43], v[48:63]
    v_mfma_f32_32x32x16_bf16 v[64:79], a[76:79], v[44:47], v[64:79]
    global_load_dwordx4 a[72:75], v114, s[24:25] offset:2048 sc1
    ds_read_b64_tr_b16 v[40:41], v101 offset:47104
    ds_read_b64_tr_b16 v[42:43], v101 offset:47616
    ds_read_b64_tr_b16 v[44:45], v102 offset:47104
    ds_read_b64_tr_b16 v[46:47], v102 offset:47616
    s_waitcnt lgkmcnt(12)
    v_mfma_f32_32x32x16_bf16 v[48:63], a[80:83], v[16:19], v[48:63]
    v_mfma_f32_32x32x16_bf16 v[64:79], a[80:83], v[20:23], v[64:79]
    global_load_dwordx4 a[76:79], v114, s[24:25] offset:3072 sc1
    ds_read_b64_tr_b16 v[16:17], v101 offset:49152
    ds_read_b64_tr_b16 v[18:19], v101 offset:49664
    ds_read_b64_tr_b16 v[20:21], v102 offset:49152
    ds_read_b64_tr_b16 v[22:23], v102 offset:49664
    s_waitcnt lgkmcnt(12)
    v_mfma_f32_32x32x16_bf16 v[48:63], a[84:87], v[24:27], v[48:63]
    v_mfma_f32_32x32x16_bf16 v[64:79], a[84:87], v[28:31], v[64:79]
    global_load_dwordx4 a[80:83], v115, s[24:25] offset:0 sc1
    ds_read_b64_tr_b16 v[24:25], v101 offset:51200
    ds_read_b64_tr_b16 v[26:27], v101 offset:51712
    ds_read_b64_tr_b16 v[28:29], v102 offset:51200
    ds_read_b64_tr_b16 v[30:31], v102 offset:51712
    s_waitcnt lgkmcnt(12)
    v_mfma_f32_32x32x16_bf16 v[48:63], a[88:91], v[32:35], v[48:63]
    v_mfma_f32_32x32x16_bf16 v[64:79], a[88:91], v[36:39], v[64:79]
    global_load_dwordx4 a[84:87], v115, s[24:25] offset:1024 sc1
    ds_read_b64_tr_b16 v[32:33], v101 offset:53248
    ds_read_b64_tr_b16 v[34:35], v101 offset:53760
    ds_read_b64_tr_b16 v[36:37], v102 offset:53248
    ds_read_b64_tr_b16 v[38:39], v102 offset:53760
    s_waitcnt lgkmcnt(12)
    v_mfma_f32_32x32x16_bf16 v[48:63], a[92:95], v[40:43], v[48:63]
    v_mfma_f32_32x32x16_bf16 v[64:79], a[92:95], v[44:47], v[64:79]
    global_load_dwordx4 a[88:91], v115, s[24:25] offset:2048 sc1
    ds_read_b64_tr_b16 v[40:41], v101 offset:55296
    ds_read_b64_tr_b16 v[42:43], v101 offset:55808
    ds_read_b64_tr_b16 v[44:45], v102 offset:55296
    ds_read_b64_tr_b16 v[46:47], v102 offset:55808
    s_waitcnt lgkmcnt(12)
    v_mfma_f32_32x32x16_bf16 v[48:63], a[96:99], v[16:19], v[48:63]
    v_mfma_f32_32x32x16_bf16 v[64:79], a[96:99], v[20:23], v[64:79]
    global_load_dwordx4 a[92:95], v115, s[24:25] offset:3072 sc1
    ds_read_b64_tr_b16 v[16:17], v101 offset:57344
    ds_read_b64_tr_b16 v[18:19], v101 offset:57856
    ds_read_b64_tr_b16 v[20:21], v102 offset:57344
    ds_read_b64_tr_b16 v[22:23], v102 offset:57856
    s_waitcnt lgkmcnt(12)
    v_mfma_f32_32x32x16_bf16 v[48:63], a[100:103], v[24:27], v[48:63]
    v_mfma_f32_32x32x16_bf16 v[64:79], a[100:103], v[28:31], v[64:79]
    global_load_dwordx4 a[96:99], v116, s[24:25] offset:0 sc1
    ds_read_b64_tr_b16 v[24:25], v101 offset:59392
    ds_read_b64_tr_b16 v[26:27], v101 offset:59904
    ds_read_b64_tr_b16 v[28:29], v102 offset:59392
    ds_read_b64_tr_b16 v[30:31], v102 offset:59904
    s_waitcnt lgkmcnt(12)
    v_mfma_f32_32x32x16_bf16 v[48:63], a[104:107], v[32:35], v[48:63]
    v_mfma_f32_32x32x16_bf16 v[64:79], a[104:107], v[36:39], v[64:79]
    global_load_dwordx4 a[100:103], v116, s[24:25] offset:1024 sc1
    ds_read_b64_tr_b16 v[32:33], v101 offset:61440
    ds_read_b64_tr_b16 v[34:35], v101 offset:61952
    ds_read_b64_tr_b16 v[36:37], v102 offset:61440
    ds_read_b64_tr_b16 v[38:39], v102 offset:61952
    s_waitcnt lgkmcnt(12)
    v_mfma_f32_32x32x16_bf16 v[48:63], a[108:111], v[40:43], v[48:63]
    v_mfma_f32_32x32x16_bf16 v[64:79], a[108:111], v[44:47], v[64:79]
    global_load_dwordx4 a[104:107], v116, s[24:25] offset:2048 sc1
    ds_read_b64_tr_b16 v[40:41], v101 offset:63488
    ds_read_b64_tr_b16 v[42:43], v101 offset:64000
    ds_read_b64_tr_b16 v[44:45], v102 offset:63488
    ds_read_b64_tr_b16 v[46:47], v102 offset:64000
    s_waitcnt lgkmcnt(12)
    v_mfma_f32_32x32x16_bf16 v[48:63], a[112:115], v[16:19], v[48:63]
    v_mfma_f32_32x32x16_bf16 v[64:79], a[112:115], v[20:23], v[64:79]
    global_load_dwordx4 a[108:111], v116, s[24:25] offset:3072 sc1
    s_waitcnt lgkmcnt(8)
    v_mfma_f32_32x32x16_bf16 v[48:63], a[116:119], v[24:27], v[48:63]
    v_mfma_f32_32x32x16_bf16 v[64:79], a[116:119], v[28:31], v[64:79]
    global_load_dwordx4 a[112:115], v117, s[24:25] offset:0 sc1
    s_waitcnt lgkmcnt(4)
    v_mfma_f32_32x32x16_bf16 v[48:63], a[120:123], v[32:35], v[48:63]
    v_mfma_f32_32x32x16_bf16 v[64:79], a[120:123], v[36:39], v[64:79]
    global_load_dwordx4 a[116:119], v117, s[24:25] offset:1024 sc1
    s_waitcnt lgkmcnt(0)
    v_mfma_f32_32x32x16_bf16 v[48:63], a[124:127], v[40:43], v[48:63]
    v_mfma_f32_32x32x16_bf16 v[64:79], a[124:127], v[44:47], v[64:79]
    global_load_dwordx4 a[120:123], v117, s[24:25] offset:2048 sc1
    s_lshl_b32 s46, s18, 3
    s_add_u32 s46, s46, s91
    s_lshl_b32 s46, s46, 5
    s_bfe_u32 s47, s90, 0x50001
    s_add_u32 s46, s46, s47
    s_lshl_b32 s46, s46, 13
    s_and_b32 s47, s90, 1
    s_lshl_b32 s47, s47, 12
    s_add_u32 s46, s46, s47
    s_add_u32 s46, s46, 50331648
    s_add_u32 s42, s94, s46
    s_addc_u32 s43, s95, 0
    global_load_dwordx4 a[124:127], v117, s[24:25] offset:3072 sc1
    v_cvt_pk_bf16_f32 v80, v48, v49
    v_cvt_pk_bf16_f32 v81, v50, v51
    v_cvt_pk_bf16_f32 v82, v56, v57
    v_cvt_pk_bf16_f32 v83, v58, v59
    global_store_dwordx4 v104, v[80:83], s[42:43] offset:0 sc1
    v_cvt_pk_bf16_f32 v84, v52, v53
    v_cvt_pk_bf16_f32 v85, v54, v55
    v_cvt_pk_bf16_f32 v86, v60, v61
    v_cvt_pk_bf16_f32 v87, v62, v63
    global_store_dwordx4 v104, v[84:87], s[42:43] offset:512 sc1
    v_cvt_pk_bf16_f32 v88, v64, v65
    v_cvt_pk_bf16_f32 v89, v66, v67
    v_cvt_pk_bf16_f32 v90, v72, v73
    v_cvt_pk_bf16_f32 v91, v74, v75
    global_store_dwordx4 v104, v[88:91], s[42:43] offset:2048 sc1
    v_cvt_pk_bf16_f32 v92, v68, v69
    v_cvt_pk_bf16_f32 v93, v70, v71
    v_cvt_pk_bf16_f32 v94, v76, v77
    v_cvt_pk_bf16_f32 v95, v78, v79
    global_store_dwordx4 v104, v[92:95], s[42:43] offset:2560 sc1
    s_waitcnt vmcnt(0)
    v_mov_b32 v108, s28
    v_mov_b32 v109, s27
    s_mov_b64 exec, 1
    global_atomic_add v108, v109, s[96:97] sc1
    s_mov_b64 exec, -1
    s_add_u32 s28, s28, 1024
    s_add_u32 s18, s18, 1
    s_cmp_lt_u32 s18, 8
    s_cbranch_scc1 L_qkv_loop_v
L_qkv_done:
    s_waitcnt vmcnt(0)
    s_barrier
    s_load_dwordx2 s[4:5], s[0:1], 40
    s_load_dwordx4 s[8:11], s[0:1], 64
    s_and_b32 s13, s90, 31
    s_lshr_b32 s14, s90, 5
    s_lshr_b32 s18, s90, 3
    s_and_b32 s19, s90, 7
    s_lshr_b32 s20, s91, 2
    s_and_b32 s21, s91, 3
    s_mov_b32 s15, 0
    s_waitcnt lgkmcnt(0)
    v_lshlrev_b32 v1, 4, v0
    s_lshl_b32 s46, s13, 17
    s_lshl_b32 s47, s91, 14
    s_add_u32 s46, s46, s47
    s_add_u32 s40, s4, s46
    s_addc_u32 s41, s5, 0
    s_add_u32 m0, s47, 0
    s_nop 0
    global_load_lds_dwordx4 v1, s[40:41] offset:0
    global_load_lds_dwordx4 v1, s[40:41] offset:1024
    global_load_lds_dwordx4 v1, s[40:41] offset:2048
    global_load_lds_dwordx4 v1, s[40:41] offset:3072
    s_add_u32 m0, s47, 4096
    s_add_u32 s40, s40, 4096
    s_addc_u32 s41, s41, 0
    global_load_lds_dwordx4 v1, s[40:41] offset:0
    global_load_lds_dwordx4 v1, s[40:41] offset:1024
    global_load_lds_dwordx4 v1, s[40:41] offset:2048
    global_load_lds_dwordx4 v1, s[40:41] offset:3072
    s_add_u32 m0, s47, 8192
    s_add_u32 s40, s40, 4096
    s_addc_u32 s41, s41, 0
    global_load_lds_dwordx4 v1, s[40:41] offset:0
    global_load_lds_dwordx4 v1, s[40:41] offset:1024
    global_load_lds_dwordx4 v1, s[40:41] offset:2048
    global_load_lds_dwordx4 v1, s[40:41] offset:3072
    s_add_u32 m0, s47, 12288
    s_add_u32 s40, s40, 4096
    s_addc_u32 s41, s41, 0
    global_load_lds_dwordx4 v1, s[40:41] offset:0
    global_load_lds_dwordx4 v1, s[40:41] offset:1024
    global_load_lds_dwordx4 v1, s[40:41] offset:2048
    global_load_lds_dwordx4 v1, s[40:41] offset:3072
    v_and_b32 v10, 15, v0
    v_lshrrev_b32 v11, 4, v0
    v_lshrrev_b32 v8, 2, v10
    v_and_b32 v9, 1, v10
    v_lshl_add_u32 v8, v8, 1, v9
    v_lshlrev_b32 v8, 8, v8
    v_lshl_add_u32 v2, v11, 4, v8
    s_and_b32 s46, s91, 3
    s_lshl_b32 s47, s46, 9
    v_lshlrev_b32 v8, 4, v10
    v_lshl_add_u32 v8, v11, 2, v8
    v_add_u32 v3, s47, v8
    s_lshr_b32 s48, s91, 2
    s_lshl_b32 s47, s48, 4
    v_lshlrev_b32 v8, 2, v11
    v_sub_u32 v8, v10, v8
    v_add_u32 v4, s47, v8
    v_add_u32 v8, s47, v10
    v_mul_u32_u24 v8, 272, v8
    v_lshl_add_u32 v8, v11, 4, v8
    s_lshl_b32 s47, s46, 6
    v_add_u32 v5, s47, v8
    v_and_b32 v8, 31, v0
    v_mul_u32_u24 v9, 272, v8
    v_lshrrev_b32 v10, 5, v0
    v_lshl_add_u32 v6, v10, 4, v9
    v_lshlrev_b32 v8, 10, v8
    v_lshl_add_u32 v8, v10, 5, v8
    s_lshl_b32 s47, s91, 7
    v_add_u32 v7, s47, v8
    v_bfe_u32 v8, v0, 2, 2
    v_lshl_add_u32 v8, v10, 2, v8
    v_lshlrev_b32 v8, 10, v8
    v_and_b32 v9, 1, v0
    v_lshl_add_u32 v8, v9, 5, v8
    v_bfe_u32 v9, v0, 4, 1
    v_lshl_add_u32 v8, v9, 4, v8
    v_bfe_u32 v9, v0, 1, 1
    v_lshl_add_u32 v8, v9, 3, v8
    v_add_u32 v8, s47, v8
    v_add_u32 v9, 0x10000, v8
    s_mov_b32 s50, 0x3e0293ee
    s_waitcnt vmcnt(0)
    s_barrier
    ds_read_b64_tr_b16 a[0:1], v8 offset:0
    ds_read_b64_tr_b16 a[2:3], v8 offset:16384
    ds_read_b64_tr_b16 a[4:5], v8 offset:8192
    ds_read_b64_tr_b16 a[6:7], v8 offset:24576
    ds_read_b64_tr_b16 a[8:9], v8 offset:32768
    ds_read_b64_tr_b16 a[10:11], v8 offset:49152
    ds_read_b64_tr_b16 a[12:13], v8 offset:40960
    ds_read_b64_tr_b16 a[14:15], v8 offset:57344
    s_waitcnt lgkmcnt(0)
    ds_read_b64_tr_b16 a[16:17], v9 offset:0
    ds_read_b64_tr_b16 a[18:19], v9 offset:16384
    ds_read_b64_tr_b16 a[20:21], v9 offset:8192
    ds_read_b64_tr_b16 a[22:23], v9 offset:24576
    ds_read_b64_tr_b16 a[24:25], v9 offset:32768
    ds_read_b64_tr_b16 a[26:27], v9 offset:49152
    ds_read_b64_tr_b16 a[28:29], v9 offset:40960
    ds_read_b64_tr_b16 a[30:31], v9 offset:57344
    s_waitcnt lgkmcnt(0)
    ds_read_b64_tr_b16 a[32:33], v8 offset:64
    ds_read_b64_tr_b16 a[34:35], v8 offset:16448
    ds_read_b64_tr_b16 a[36:37], v8 offset:8256
    ds_read_b64_tr_b16 a[38:39], v8 offset:24640
    ds_read_b64_tr_b16 a[40:41], v8 offset:32832
    ds_read_b64_tr_b16 a[42:43], v8 offset:49216
    ds_read_b64_tr_b16 a[44:45], v8 offset:41024
    ds_read_b64_tr_b16 a[46:47], v8 offset:57408
    s_waitcnt lgkmcnt(0)
    ds_read_b64_tr_b16 a[48:49], v9 offset:64
    ds_read_b64_tr_b16 a[50:51], v9 offset:16448
    ds_read_b64_tr_b16 a[52:53], v9 offset:8256
    ds_read_b64_tr_b16 a[54:55], v9 offset:24640
    ds_read_b64_tr_b16 a[56:57], v9 offset:32832
    ds_read_b64_tr_b16 a[58:59], v9 offset:49216
    ds_read_b64_tr_b16 a[60:61], v9 offset:41024
    ds_read_b64_tr_b16 a[62:63], v9 offset:57408
    s_waitcnt lgkmcnt(0)
    s_barrier
    s_cmp_lg_u32 s20, 0
    s_cbranch_scc1 g1h_17
    v_and_b32 v16, 7, v0
    v_bfe_u32 v17, v0, 4, 1
    v_lshlrev_b32 v17, 2, v17
    v_xor_b32 v16, v16, v17
    v_lshrrev_b32 v17, 3, v0
    v_mul_u32_u24 v17, 3584, v17
    v_lshl_add_u32 v124, v16, 4, v17
    s_mul_i32 s40, s21, 28672
    s_lshl_b32 s41, s18, 7
    s_add_u32 s40, s40, s41
    s_add_u32 s22, s8, s40
    s_addc_u32 s23, s9, 0
    s_mov_b32 s24, 114688
    s_branch g1e_18
g1h_17:
    v_and_b32 v16, 7, v0
    v_bfe_u32 v17, v0, 4, 1
    v_lshlrev_b32 v17, 2, v17
    v_xor_b32 v16, v16, v17
    v_lshrrev_b32 v17, 3, v0
    v_mul_u32_u24 v17, 1024, v17
    v_lshl_add_u32 v124, v16, 4, v17
    s_lshl_b32 s40, s21, 13
    s_lshl_b32 s41, s19, 7
    s_add_u32 s40, s40, s41
    s_add_u32 s40, s40, 7340032
    s_add_u32 s22, s94, s40
    s_addc_u32 s23, s95, 0
    s_mov_b32 s24, 32768
g1e_18:
    s_lshl_b32 s25, s91, 10
    s_add_u32 s25, s25, 32768
    v_lshrrev_b32 v16, 5, v0
    v_bfe_u32 v17, v0, 2, 2
    v_lshl_add_u32 v16, v16, 3, v17
    v_lshlrev_b32 v16, 7, v16
    v_bfe_u32 v17, v0, 3, 1
    v_lshl_add_u32 v16, v17, 6, v16
    v_and_b32 v17, 1, v0
    v_lshl_add_u32 v16, v17, 5, v16
    v_bfe_u32 v17, v0, 4, 1
    v_lshl_add_u32 v16, v17, 4, v16
    v_bfe_u32 v17, v0, 1, 1
    v_lshl_add_u32 v125, v17, 3, v16
    v_lshrrev_b32 v16, 5, v0
    v_bfe_u32 v17, v0, 2, 2
    v_lshl_add_u32 v16, v16, 3, v17
    v_lshlrev_b32 v16, 7, v16
    v_bfe_u32 v17, v0, 3, 1
    v_lshl_add_u32 v16, v17, 6, v16
    v_bfe_u32 v17, v0, 4, 1
    v_lshl_add_u32 v16, v17, 5, v16
    v_and_b32 v17, 3, v0
    v_lshl_add_u32 v126, v17, 3, v16
    s_lshr_b32 s40, s21, 1
    s_lshl_b32 s40, s40, 6
    v_xor_b32 v125, s40, v125
    s_and_b32 s40, s21, 1
    s_lshl_b32 s40, s40, 6
    v_xor_b32 v126, s40, v126
    s_lshl_b32 s40, s20, 11
    s_add_u32 s40, s40, 32768
    v_add_u32 v125, s40, v125
    s_add_u32 s40, s40, 4096
    v_add_u32 v126, s40, v126
    v_accvgpr_write_b32 a64, 0
    v_accvgpr_write_b32 a65, 0
    v_accvgpr_write_b32 a66, 0
    v_accvgpr_write_b32 a67, 0
    v_accvgpr_write_b32 a68, 0
    v_accvgpr_write_b32 a69, 0
    v_accvgpr_write_b32 a70, 0
    v_accvgpr_write_b32 a71, 0
    v_accvgpr_write_b32 a72, 0
    v_accvgpr_write_b32 a73, 0
    v_accvgpr_write_b32 a74, 0
    v_accvgpr_write_b32 a75, 0
    v_accvgpr_write_b32 a76, 0
    v_accvgpr_write_b32 a77, 0
    v_accvgpr_write_b32 a78, 0
    v_accvgpr_write_b32 a79, 0
L_att_loop:
    s_cmp_lt_u32 s14, 57
    s_cbranch_scc1 L_notouch
    s_cmp_lg_u32 s91, 6
    s_cbranch_scc1 tc_19
    s_getpc_b64 s[86:87]
tcp_20:
    s_sub_u32 s86, s86, tcp_20-adaLN_cond__memory_aug_recurrent_mem_tr__mixer_token_mlp__prompt_kernel
    s_subb_u32 s87, s87, 0
    v_lshlrev_b32 v16, 7, v0
    s_mov_b32 s88, (L_code_end-adaLN_cond__memory_aug_recurrent_mem_tr__mixer_token_mlp__prompt_kernel+8191)/8192
tcl_21:
    v_min_u32 v17, L_code_end-adaLN_cond__memory_aug_recurrent_mem_tr__mixer_token_mlp__prompt_kernel-4, v16
    global_load_dword v18, v17, s[86:87]
    v_add_u32 v16, 8192, v16
    s_sub_u32 s88, s88, 1
    s_cmp_lg_u32 s88, 0
    s_cbranch_scc1 tcl_21
    s_waitcnt vmcnt(0)
tc_19:
L_notouch:
    s_cmp_lg_u32 s91, 0
    s_cbranch_scc1 wgw_22
    s_lshl_b32 s40, s14, 7
    s_lshl_b32 s41, s13, 2
    s_add_u32 s40, s40, s41
    v_mov_b32 v16, s40
    s_mov_b32 s98, 8000
wp_23:
    global_load_dword v17, v16, s[96:97] sc1
    s_waitcnt vmcnt(0)
    v_cmp_eq_u32 vcc, 516, v17
    s_cbranch_vccnz wpok_24
    s_sleep 2
    s_sub_u32 s98, s98, 1
    s_cbranch_scc0 wp_23
    s_branch L_err
wpok_24:
wgw_22:
    s_barrier
    s_lshl_b32 s46, s14, 5
    s_add_u32 s46, s46, s13
    s_lshl_b32 s47, s46, 13
    s_add_u32 s48, s47, 33558528
    s_add_u32 s40, s94, s48
    s_addc_u32 s41, s95, 0
    global_load_dwordx4 v[32:35], v1, s[40:41] offset:-4096 sc1
    global_load_dwordx4 v[36:39], v1, s[40:41] offset:-3072 sc1
    global_load_dwordx4 v[40:43], v1, s[40:41] offset:-2048 sc1
    global_load_dwordx4 v[44:47], v1, s[40:41] offset:-1024 sc1
    global_load_dwordx4 v[48:51], v1, s[40:41] offset:0 sc1
    global_load_dwordx4 v[52:55], v1, s[40:41] offset:1024 sc1
    global_load_dwordx4 v[56:59], v1, s[40:41] offset:2048 sc1
    global_load_dwordx4 v[60:63], v1, s[40:41] offset:3072 sc1
    s_lshr_b32 s48, s91, 2
    s_lshl_b32 s48, s48, 12
    s_add_u32 s48, s48, s47
    s_add_u32 s48, s48, 16777216
    s_add_u32 s40, s94, s48
    s_addc_u32 s41, s95, 0
    global_load_dwordx4 v[16:19], v1, s[40:41] offset:0 sc1
    global_load_dwordx4 v[20:23], v1, s[40:41] offset:1024 sc1
    global_load_dwordx4 v[24:27], v1, s[40:41] offset:2048 sc1
    global_load_dwordx4 v[28:31], v1, s[40:41] offset:3072 sc1
    s_and_b32 s48, s91, 3
    s_lshl_b32 s48, s48, 11
    s_add_u32 s48, s48, s47
    s_add_u32 s48, s48, 50331648
    s_add_u32 s40, s94, s48
    s_addc_u32 s41, s95, 0
    global_load_dwordx4 v[80:83], v1, s[40:41] offset:0 sc1
    global_load_dwordx4 v[84:87], v1, s[40:41] offset:1024 sc1
    v_mov_b32 v89, 0
    v_mov_b32 v91, 0
    v_mov_b32 v121, 0
    v_mov_b32 v116, 0x3f803f80
    v_mov_b32 v117, 0x3f803f80
    v_mov_b32 v118, 0x3f803f80
    v_mov_b32 v119, 0x3f803f80
    s_waitcnt vmcnt(2)
    v_mfma_f32_16x16x32_bf16 v[92:95], v[32:35], v[16:19], 0
    v_mfma_f32_16x16x32_bf16 v[96:99], v[48:51], v[16:19], 0
    v_mfma_f32_16x16x32_bf16 v[92:95], v[36:39], v[20:23], v[92:95]
    v_mfma_f32_16x16x32_bf16 v[96:99], v[52:55], v[20:23], v[96:99]
    v_mfma_f32_16x16x32_bf16 v[92:95], v[40:43], v[24:27], v[92:95]
    v_mfma_f32_16x16x32_bf16 v[96:99], v[56:59], v[24:27], v[96:99]
    v_mfma_f32_16x16x32_bf16 v[92:95], v[44:47], v[28:31], v[92:95]
    v_mfma_f32_16x16x32_bf16 v[96:99], v[60:63], v[28:31], v[96:99]
midl_25:
    s_cmp_lg_u32 s91, 0
    s_cbranch_scc1 g1w_27
    s_mov_b32 s98, 8000
g1p_28:
    v_and_b32 v64, 7, v0
    v_add_u32 v64, s15, v64
    v_cmp_gt_u32 s[40:41], 64, v64
    v_min_u32 v64, 63, v64
    v_lshlrev_b32 v64, 7, v64
    v_add_u32 v64, 20480, v64
    global_load_dword v65, v64, s[96:97] sc1
    s_lshl_b32 s43, s13, 7
    s_add_u32 s43, s43, 8192
    v_mov_b32 v66, s43
    global_load_dword v67, v66, s[96:97] sc1
    s_waitcnt vmcnt(0)
    v_cmp_le_u32 vcc, 32, v65
    s_nop 0
    s_and_b32 s40, s40, vcc_lo
    s_and_b32 s40, s40, 0xff
    s_not_b32 s40, s40
    s_ff1_i32_b32 s42, s40
    v_readfirstlane_b32 s43, v67
    s_nop 0
    s_add_u32 s44, s43, 1
    s_cmp_ge_u32 s44, s14
    s_cselect_b32 s42, 0, s42
    s_cmp_gt_u32 s43, s14
    s_cselect_b32 s42, 0x100, s42
    s_cmp_lg_u32 s42, 0
    s_cbranch_scc1 g1go_29
    s_sleep 1
    s_sub_u32 s98, s98, 1
    s_cbranch_scc0 g1p_28
    s_branch L_err
g1go_29:
    v_mov_b32 v64, s42
    v_mov_b32 v65, 163776
    ds_write_b32 v65, v64
    s_waitcnt lgkmcnt(0)
g1w_27:
    s_barrier
    v_mov_b32 v65, 163776
    ds_read_b32 v64, v65
    s_waitcnt lgkmcnt(0)
    v_readfirstlane_b32 s42, v64
    s_barrier
    s_and_b32 s43, s42, 0xff
    s_cbranch_scc0 g1x_26
    s_mov_b32 s43, 0
    s_mov_b32 s44, s25
g1d_30:
    s_mov_b32 m0, s44
    s_nop 0
    global_load_lds_dwordx4 v124, s[22:23] sc1
    s_add_u32 s22, s22, s24
    s_addc_u32 s23, s23, 0
    s_add_u32 s44, s44, 8192
    s_add_u32 s43, s43, 1
    s_cmp_lt_u32 s43, s42
    s_cbranch_scc1 g1d_30
    s_waitcnt vmcnt(0)
    s_barrier
    v_mov_b32 v64, v125
    v_mov_b32 v65, v126
    s_mov_b32 s43, 0
g1m_31:
    ds_read_b64_tr_b16 v[68:69], v64 offset:0
    ds_read_b64_tr_b16 v[72:73], v65 offset:0
    ds_read_b64_tr_b16 v[70:71], v64 offset:512
    ds_read_b64_tr_b16 v[74:75], v65 offset:512
    v_add_u32 v64, 8192, v64
    v_add_u32 v65, 8192, v65
    s_waitcnt lgkmcnt(0)
    v_mfma_f32_32x32x16_bf16 a[64:79], v[68:71], v[72:75], a[64:79]
    s_add_u32 s43, s43, 1
    s_cmp_lt_u32 s43, s42
    s_cbranch_scc1 g1m_31
    s_add_u32 s15, s15, s42
g1x_26:
    s_cmp_lg_u32 s42, 0x100
    s_cbranch_scc1 midl_25
    s_lshl_b32 s48, s46, 11
    s_add_u32 s49, s48, 69206016
    s_add_u32 s40, s94, s49
    s_addc_u32 s41, s95, 0
    global_load_dwordx4 v[64:67], v2, s[40:41] offset:0 sc1
    global_load_dwordx4 v[68:71], v2, s[40:41] offset:64 sc1
    global_load_dwordx4 v[72:75], v2, s[40:41] offset:128 sc1
    global_load_dwordx4 v[76:79], v2, s[40:41] offset:192 sc1
    s_add_u32 s49, s48, 73400320
    s_add_u32 s40, s94, s49
    s_addc_u32 s41, s95, 0
    global_load_dword v88, v3, s[40:41] offset:0 sc1
    global_load_dword v90, v3, s[40:41] offset:256 sc1
    s_waitcnt vmcnt(2)
    v_mfma_f32_16x16x32_bf16 v[100:103], v[64:67], v[16:19], 0
    v_mfma_f32_16x16x32_bf16 v[100:103], v[68:71], v[20:23], v[100:103]
    v_mfma_f32_16x16x32_bf16 v[100:103], v[72:75], v[24:27], v[100:103]
    v_mfma_f32_16x16x32_bf16 v[100:103], v[76:79], v[28:31], v[100:103]
    v_mov_b32 v10, 0xff800000
    v_cmp_le_i32 vcc, 0, v4
    s_nop 1
    v_cndmask_b32 v92, v10, v92, vcc
    v_cmp_le_i32 vcc, 1, v4
    s_nop 1
    v_cndmask_b32 v93, v10, v93, vcc
    v_cmp_le_i32 vcc, 2, v4
    s_nop 1
    v_cndmask_b32 v94, v10, v94, vcc
    v_cmp_le_i32 vcc, 3, v4
    s_nop 1
    v_cndmask_b32 v95, v10, v95, vcc
    v_cmp_le_i32 vcc, 16, v4
    s_nop 1
    v_cndmask_b32 v96, v10, v96, vcc
    v_cmp_le_i32 vcc, 17, v4
    s_nop 1
    v_cndmask_b32 v97, v10, v97, vcc
    v_cmp_le_i32 vcc, 18, v4
    s_nop 1
    v_cndmask_b32 v98, v10, v98, vcc
    v_cmp_le_i32 vcc, 19, v4
    s_nop 1
    v_cndmask_b32 v99, v10, v99, vcc
    v_max3_f32 v8, v92, v93, v94
    v_max3_f32 v9, v95, v96, v97
    v_max3_f32 v8, v8, v98, v99
    v_max3_f32 v9, v9, v100, v101
    v_max_f32 v8, v8, v9
    v_mov_b32 v9, v8
    s_nop 1
    v_permlane32_swap_b32 v8, v9
    v_max_f32 v8, v8, v9
    v_mov_b32 v9, v8
    s_nop 1
    v_permlane16_swap_b32 v8, v9
    v_max_f32 v8, v8, v9
    v_mul_f32 v8, s50, v8
    v_fma_f32 v92, v92, s50, -v8
    v_exp_f32 v92, v92
    v_fma_f32 v93, v93, s50, -v8
    v_exp_f32 v93, v93
    v_fma_f32 v94, v94, s50, -v8
    v_exp_f32 v94, v94
    v_fma_f32 v95, v95, s50, -v8
    v_exp_f32 v95, v95
    v_fma_f32 v96, v96, s50, -v8
    v_exp_f32 v96, v96
    v_fma_f32 v97, v97, s50, -v8
    v_exp_f32 v97, v97
    v_fma_f32 v98, v98, s50, -v8
    v_exp_f32 v98, v98
    v_fma_f32 v99, v99, s50, -v8
    v_exp_f32 v99, v99
    v_fma_f32 v100, v100, s50, -v8
    v_exp_f32 v100, v100
    v_fma_f32 v101, v101, s50, -v8
    v_exp_f32 v101, v101
    v_cvt_pk_bf16_f32 v92, v92, v93
    v_cvt_pk_bf16_f32 v93, v94, v95
    v_cvt_pk_bf16_f32 v94, v96, v97
    v_cvt_pk_bf16_f32 v95, v98, v99
    v_cvt_pk_bf16_f32 v120, v100, v101
    s_waitcnt vmcnt(0)
    v_mfma_f32_16x16x32_bf16 v[112:115], v[116:119], v[92:95], 0
    v_mfma_f32_16x16x32_bf16 v[104:107], v[80:83], v[92:95], 0
    v_mfma_f32_16x16x32_bf16 v[108:111], v[84:87], v[92:95], 0
    v_mfma_f32_16x16x16_bf16 v[112:115], v[116:117], v[120:121], v[112:115]
    v_mfma_f32_16x16x16_bf16 v[104:107], v[88:89], v[120:121], v[104:107]
    v_mfma_f32_16x16x16_bf16 v[108:111], v[90:91], v[120:121], v[108:111]
    s_nop 5
    v_rcp_f32 v9, v112
    s_nop 0
    v_mul_f32 v104, v104, v9
    v_mul_f32 v105, v105, v9
    v_mul_f32 v106, v106, v9
    v_mul_f32 v107, v107, v9
    v_mul_f32 v108, v108, v9
    v_mul_f32 v109, v109, v9
    v_mul_f32 v110, v110, v9
    v_mul_f32 v111, v111, v9
    v_cvt_pk_bf16_f32 v96, v104, v105
    v_cvt_pk_bf16_f32 v97, v106, v107
    v_cvt_pk_bf16_f32 v98, v108, v109
    v_cvt_pk_bf16_f32 v99, v110, v111
    s_barrier
    ds_write_b128 v5, v[96:99]
    s_waitcnt lgkmcnt(0)
    s_barrier
    ds_read_b128 v[16:19], v6 offset:0
    ds_read_b128 v[20:23], v6 offset:32
    ds_read_b128 v[24:27], v6 offset:64
    ds_read_b128 v[28:31], v6 offset:96
    ds_read_b128 v[32:35], v6 offset:128
    ds_read_b128 v[36:39], v6 offset:160
    ds_read_b128 v[40:43], v6 offset:192
    ds_read_b128 v[44:47], v6 offset:224
    s_waitcnt lgkmcnt(7)
    v_mfma_f32_32x32x16_bf16 v[48:63], a[0:3], v[16:19], 0
    v_mfma_f32_32x32x16_bf16 v[64:79], a[32:35], v[16:19], 0
    s_waitcnt lgkmcnt(6)
    v_mfma_f32_32x32x16_bf16 v[48:63], a[4:7], v[20:23], v[48:63]
    v_mfma_f32_32x32x16_bf16 v[64:79], a[36:39], v[20:23], v[64:79]
    s_waitcnt lgkmcnt(5)
    v_mfma_f32_32x32x16_bf16 v[48:63], a[8:11], v[24:27], v[48:63]
    v_mfma_f32_32x32x16_bf16 v[64:79], a[40:43], v[24:27], v[64:79]
    s_waitcnt lgkmcnt(4)
    v_mfma_f32_32x32x16_bf16 v[48:63], a[12:15], v[28:31], v[48:63]
    v_mfma_f32_32x32x16_bf16 v[64:79], a[44:47], v[28:31], v[64:79]
    s_waitcnt lgkmcnt(3)
    v_mfma_f32_32x32x16_bf16 v[48:63], a[16:19], v[32:35], v[48:63]
    v_mfma_f32_32x32x16_bf16 v[64:79], a[48:51], v[32:35], v[64:79]
    s_waitcnt lgkmcnt(2)
    v_mfma_f32_32x32x16_bf16 v[48:63], a[20:23], v[36:39], v[48:63]
    v_mfma_f32_32x32x16_bf16 v[64:79], a[52:55], v[36:39], v[64:79]
    s_waitcnt lgkmcnt(1)
    v_mfma_f32_32x32x16_bf16 v[48:63], a[24:27], v[40:43], v[48:63]
    v_mfma_f32_32x32x16_bf16 v[64:79], a[56:59], v[40:43], v[64:79]
    s_waitcnt lgkmcnt(0)
    v_mfma_f32_32x32x16_bf16 v[48:63], a[28:31], v[44:47], v[48:63]
    v_mfma_f32_32x32x16_bf16 v[64:79], a[60:63], v[44:47], v[64:79]
    s_lshl_b32 s47, s46, 15
    s_add_u32 s47, s47, 83886080
    s_add_u32 s40, s94, s47
    s_addc_u32 s41, s95, 0
    v_lshrrev_b32 v8, 10, v7
    v_lshlrev_b32 v8, 4, v8
    v_add_u32 v8, v8, v7
    v_add_u32 v8, 98304, v8
    s_nop 2
    v_cvt_pk_bf16_f32 v80, v48, v49
    v_cvt_pk_bf16_f32 v81, v50, v51
    v_cvt_pk_bf16_f32 v82, v52, v53
    v_cvt_pk_bf16_f32 v83, v54, v55
    v_cvt_pk_bf16_f32 v84, v56, v57
    v_cvt_pk_bf16_f32 v85, v58, v59
    v_cvt_pk_bf16_f32 v86, v60, v61
    v_cvt_pk_bf16_f32 v87, v62, v63
    ds_write_b128 v8, v[80:83] offset:0
    ds_write_b128 v8, v[84:87] offset:16
    v_cvt_pk_bf16_f32 v88, v64, v65
    v_cvt_pk_bf16_f32 v89, v66, v67
    v_cvt_pk_bf16_f32 v90, v68, v69
    v_cvt_pk_bf16_f32 v91, v70, v71
    v_cvt_pk_bf16_f32 v92, v72, v73
    v_cvt_pk_bf16_f32 v93, v74, v75
    v_cvt_pk_bf16_f32 v94, v76, v77
    v_cvt_pk_bf16_f32 v95, v78, v79
    ds_write_b128 v8, v[88:91] offset:64
    ds_write_b128 v8, v[92:95] offset:80
    s_mul_i32 s47, s91, 4160
    s_add_u32 s47, s47, 98304
    v_add_u32 v8, s47, v1
    s_lshl_b32 s47, s91, 12
    v_add_u32 v9, s47, v1
    s_waitcnt lgkmcnt(0)
    s_barrier
    ds_read_b128 v[80:83], v8 offset:0
    ds_read_b128 v[84:87], v8 offset:1040
    ds_read_b128 v[88:91], v8 offset:2080
    ds_read_b128 v[92:95], v8 offset:3120
    s_waitcnt lgkmcnt(3)
    global_store_dwordx4 v9, v[80:83], s[40:41] offset:0 sc1
    s_waitcnt lgkmcnt(2)
    global_store_dwordx4 v9, v[84:87], s[40:41] offset:1024 sc1
    s_waitcnt lgkmcnt(1)
    global_store_dwordx4 v9, v[88:91], s[40:41] offset:2048 sc1
    s_waitcnt lgkmcnt(0)
    global_store_dwordx4 v9, v[92:95], s[40:41] offset:3072 sc1
    s_lshl_b32 s26, s14, 7
    s_add_u32 s26, s26, 12288
    s_waitcnt vmcnt(0)
    s_barrier
    s_cmp_lg_u32 s91, 0
    s_cbranch_scc1 wgs_32
    v_mov_b32 v10, s26
    v_mov_b32 v11, 1
    s_mov_b64 exec, 1
    global_atomic_add v10, v11, s[96:97] sc1
    s_mov_b64 exec, -1
wgs_32:
    s_cmp_ge_u32 s14, 50
    s_cbranch_scc1 L_skip_g1
    s_cmp_lg_u32 s91, 0
    s_cbranch_scc1 g1w_34
    s_mov_b32 s98, 8000
g1p_35:
    v_and_b32 v64, 7, v0
    v_add_u32 v64, s15, v64
    v_cmp_gt_u32 s[40:41], 64, v64
    v_min_u32 v64, 63, v64
    v_lshlrev_b32 v64, 7, v64
    v_add_u32 v64, 20480, v64
    global_load_dword v65, v64, s[96:97] sc1
    s_waitcnt vmcnt(0)
    v_cmp_le_u32 vcc, 32, v65
    s_nop 0
    s_and_b32 s40, s40, vcc_lo
    s_and_b32 s40, s40, 0xff
    s_not_b32 s40, s40
    s_ff1_i32_b32 s42, s40
    v_mov_b32 v64, s42
    v_mov_b32 v65, 163776
    ds_write_b32 v65, v64
    s_waitcnt lgkmcnt(0)
g1w_34:
    s_barrier
    v_mov_b32 v65, 163776
    ds_read_b32 v64, v65
    s_waitcnt lgkmcnt(0)
    v_readfirstlane_b32 s42, v64
    s_barrier
    s_and_b32 s43, s42, 0xff
    s_cbranch_scc0 g1x_33
    s_mov_b32 s43, 0
    s_mov_b32 s44, s25
g1d_36:
    s_mov_b32 m0, s44
    s_nop 0
    global_load_lds_dwordx4 v124, s[22:23] sc1
    s_add_u32 s22, s22, s24
    s_addc_u32 s23, s23, 0
    s_add_u32 s44, s44, 8192
    s_add_u32 s43, s43, 1
    s_cmp_lt_u32 s43, s42
    s_cbranch_scc1 g1d_36
    s_waitcnt vmcnt(0)
    s_barrier
    v_mov_b32 v64, v125
    v_mov_b32 v65, v126
    s_mov_b32 s43, 0
g1m_37:
    ds_read_b64_tr_b16 v[68:69], v64 offset:0
    ds_read_b64_tr_b16 v[72:73], v65 offset:0
    ds_read_b64_tr_b16 v[70:71], v64 offset:512
    ds_read_b64_tr_b16 v[74:75], v65 offset:512
    v_add_u32 v64, 8192, v64
    v_add_u32 v65, 8192, v65
    s_waitcnt lgkmcnt(0)
    v_mfma_f32_32x32x16_bf16 a[64:79], v[68:71], v[72:75], a[64:79]
    s_add_u32 s43, s43, 1
    s_cmp_lt_u32 s43, s42
    s_cbranch_scc1 g1m_37
    s_add_u32 s15, s15, s42
g1x_33:
L_skip_g1:
    s_cmp_lg_u32 s91, 0
    s_cbranch_scc1 wgw_38
    v_mov_b32 v16, s26
    s_mov_b32 s98, 8000
wp_39:
    global_load_dword v17, v16, s[96:97] sc1
    s_waitcnt vmcnt(0)
    v_cmp_le_u32 vcc, 32, v17
    s_cbranch_vccnz wpok_40
    s_sleep 1
    s_sub_u32 s98, s98, 1
    s_cbranch_scc0 wp_39
    s_branch L_err
wpok_40:
wgw_38:
    s_barrier
    s_load_dwordx2 s[46:47], s[0:1], 0
    s_lshl_b32 s41, s14, 20
    s_lshl_b32 s43, s91, 17
    s_add_u32 s41, s41, s43
    s_lshl_b32 s43, s13, 10
    s_add_u32 s41, s41, s43
    s_add_u32 s41, s41, 83886080
    s_add_u32 s44, s94, s41
    s_addc_u32 s45, s95, 0
    global_load_dwordx4 v[16:19], v1, s[44:45] sc1
    s_add_u32 s44, s44, 32768
    s_addc_u32 s45, s45, 0
    global_load_dwordx4 v[20:23], v1, s[44:45] sc1
    s_add_u32 s44, s44, 32768
    s_addc_u32 s45, s45, 0
    global_load_dwordx4 v[24:27], v1, s[44:45] sc1
    s_add_u32 s44, s44, 32768
    s_addc_u32 s45, s45, 0
    global_load_dwordx4 v[28:31], v1, s[44:45] sc1
    s_lshl_b32 s41, s14, 15
    s_add_u32 s41, s41, s43
    v_add_u32 v11, s41, v1
    s_waitcnt lgkmcnt(0)
    global_load_dwordx4 v[88:91], v11, s[46:47]
    s_add_u32 s44, s94, 6144
    s_addc_u32 s45, s95, 0
    v_lshlrev_b32 v8, 5, v0
    global_load_dwordx4 v[96:99], v8, s[44:45] offset:-2048 sc1
    global_load_dwordx4 v[100:103], v8, s[44:45] offset:-2032 sc1
    global_load_dwordx4 v[104:107], v8, s[44:45] offset:0 sc1
    global_load_dwordx4 v[108:111], v8, s[44:45] offset:16 sc1
    global_load_dwordx4 v[112:115], v8, s[44:45] offset:2048 sc1
    global_load_dwordx4 v[116:119], v8, s[44:45] offset:2064 sc1
    s_mov_b32 s46, 0x00003f80
    s_mov_b32 s47, 0x3f800000
    v_mov_b32 v80, 0
    v_mov_b32 v81, 0
    v_mov_b32 v82, 0
    v_mov_b32 v83, 0
    v_mov_b32 v84, 0
    v_mov_b32 v85, 0
    v_mov_b32 v86, 0
    v_mov_b32 v87, 0
    s_waitcnt vmcnt(10)
    v_dot2_f32_bf16 v80, v16, s46, v80
    v_dot2_f32_bf16 v81, v16, s47, v81
    v_dot2_f32_bf16 v82, v17, s46, v82
    v_dot2_f32_bf16 v83, v17, s47, v83
    v_dot2_f32_bf16 v84, v18, s46, v84
    v_dot2_f32_bf16 v85, v18, s47, v85
    v_dot2_f32_bf16 v86, v19, s46, v86
    v_dot2_f32_bf16 v87, v19, s47, v87
    s_waitcnt vmcnt(9)
    v_dot2_f32_bf16 v80, v20, s46, v80
    v_dot2_f32_bf16 v81, v20, s47, v81
    v_dot2_f32_bf16 v82, v21, s46, v82
    v_dot2_f32_bf16 v83, v21, s47, v83
    v_dot2_f32_bf16 v84, v22, s46, v84
    v_dot2_f32_bf16 v85, v22, s47, v85
    v_dot2_f32_bf16 v86, v23, s46, v86
    v_dot2_f32_bf16 v87, v23, s47, v87
    s_waitcnt vmcnt(8)
    v_dot2_f32_bf16 v80, v24, s46, v80
    v_dot2_f32_bf16 v81, v24, s47, v81
    v_dot2_f32_bf16 v82, v25, s46, v82
    v_dot2_f32_bf16 v83, v25, s47, v83
    v_dot2_f32_bf16 v84, v26, s46, v84
    v_dot2_f32_bf16 v85, v26, s47, v85
    v_dot2_f32_bf16 v86, v27, s46, v86
    v_dot2_f32_bf16 v87, v27, s47, v87
    s_waitcnt vmcnt(7)
    v_dot2_f32_bf16 v80, v28, s46, v80
    v_dot2_f32_bf16 v81, v28, s47, v81
    v_dot2_f32_bf16 v82, v29, s46, v82
    v_dot2_f32_bf16 v83, v29, s47, v83
    v_dot2_f32_bf16 v84, v30, s46, v84
    v_dot2_f32_bf16 v85, v30, s47, v85
    v_dot2_f32_bf16 v86, v31, s46, v86
    v_dot2_f32_bf16 v87, v31, s47, v87
    s_lshl_b32 s41, s91, 11
    v_add_u32 v8, s41, v1
    s_nop 2
    ds_write_b128 v8, v[80:83] offset:16384
    ds_write_b128 v8, v[84:87] offset:17408
    s_waitcnt lgkmcnt(0)
    s_barrier
    s_cmp_lg_u32 s91, 0
    s_cbranch_scc1 redr_end_41
    ds_read_b128 v[16:19], v1 offset:18432
    ds_read_b128 v[20:23], v1 offset:19456
    ds_read_b128 v[24:27], v1 offset:20480
    ds_read_b128 v[28:31], v1 offset:21504
    ds_read_b128 v[32:35], v1 offset:22528
    ds_read_b128 v[36:39], v1 offset:23552
    ds_read_b128 v[40:43], v1 offset:24576
    ds_read_b128 v[44:47], v1 offset:25600
    ds_read_b128 v[48:51], v1 offset:26624
    ds_read_b128 v[52:55], v1 offset:27648
    ds_read_b128 v[56:59], v1 offset:28672
    ds_read_b128 v[60:63], v1 offset:29696
    ds_read_b128 v[64:67], v1 offset:30720
    ds_read_b128 v[68:71], v1 offset:31744
    s_waitcnt vmcnt(0)
    v_lshlrev_b32 v72, 16, v88
    v_and_b32 v73, 0xffff0000, v88
    v_lshlrev_b32 v74, 16, v89
    v_and_b32 v75, 0xffff0000, v89
    v_lshlrev_b32 v76, 16, v90
    v_and_b32 v77, 0xffff0000, v90
    v_lshlrev_b32 v78, 16, v91
    v_and_b32 v79, 0xffff0000, v91
    s_waitcnt lgkmcnt(12)
    v_add_f32 v80, v80, v16
    v_add_f32 v81, v81, v17
    v_add_f32 v82, v82, v18
    v_add_f32 v83, v83, v19
    v_add_f32 v84, v84, v20
    v_add_f32 v85, v85, v21
    v_add_f32 v86, v86, v22
    v_add_f32 v87, v87, v23
    s_waitcnt lgkmcnt(10)
    v_add_f32 v80, v80, v24
    v_add_f32 v81, v81, v25
    v_add_f32 v82, v82, v26
    v_add_f32 v83, v83, v27
    v_add_f32 v84, v84, v28
    v_add_f32 v85, v85, v29
    v_add_f32 v86, v86, v30
    v_add_f32 v87, v87, v31
    s_waitcnt lgkmcnt(8)
    v_add_f32 v80, v80, v32
    v_add_f32 v81, v81, v33
    v_add_f32 v82, v82, v34
    v_add_f32 v83, v83, v35
    v_add_f32 v84, v84, v36
    v_add_f32 v85, v85, v37
    v_add_f32 v86, v86, v38
    v_add_f32 v87, v87, v39
    s_waitcnt lgkmcnt(6)
    v_add_f32 v80, v80, v40
    v_add_f32 v81, v81, v41
    v_add_f32 v82, v82, v42
    v_add_f32 v83, v83, v43
    v_add_f32 v84, v84, v44
    v_add_f32 v85, v85, v45
    v_add_f32 v86, v86, v46
    v_add_f32 v87, v87, v47
    s_waitcnt lgkmcnt(4)
    v_add_f32 v80, v80, v48
    v_add_f32 v81, v81, v49
    v_add_f32 v82, v82, v50
    v_add_f32 v83, v83, v51
    v_add_f32 v84, v84, v52
    v_add_f32 v85, v85, v53
    v_add_f32 v86, v86, v54
    v_add_f32 v87, v87, v55
    s_waitcnt lgkmcnt(2)
    v_add_f32 v80, v80, v56
    v_add_f32 v81, v81, v57
    v_add_f32 v82, v82, v58
    v_add_f32 v83, v83, v59
    v_add_f32 v84, v84, v60
    v_add_f32 v85, v85, v61
    v_add_f32 v86, v86, v62
    v_add_f32 v87, v87, v63
    s_waitcnt lgkmcnt(0)
    v_add_f32 v80, v80, v64
    v_add_f32 v81, v81, v65
    v_add_f32 v82, v82, v66
    v_add_f32 v83, v83, v67
    v_add_f32 v84, v84, v68
    v_add_f32 v85, v85, v69
    v_add_f32 v86, v86, v70
    v_add_f32 v87, v87, v71
    v_fmac_f32 v72, v80, v96
    v_fmac_f32 v73, v81, v97
    v_fmac_f32 v74, v82, v98
    v_fmac_f32 v75, v83, v99
    v_fmac_f32 v76, v84, v100
    v_fmac_f32 v77, v85, v101
    v_fmac_f32 v78, v86, v102
    v_fmac_f32 v79, v87, v103
    v_cvt_pk_bf16_f32 v88, v72, v73
    v_cvt_pk_bf16_f32 v89, v74, v75
    v_cvt_pk_bf16_f32 v90, v76, v77
    v_cvt_pk_bf16_f32 v91, v78, v79
    s_add_u32 s44, s94, 4194304
    s_addc_u32 s45, s95, 0
    global_store_dwordx4 v11, v[88:91], s[44:45] sc1
    v_lshlrev_b32 v72, 16, v88
    v_and_b32 v73, 0xffff0000, v88
    v_lshlrev_b32 v74, 16, v89
    v_and_b32 v75, 0xffff0000, v89
    v_lshlrev_b32 v76, 16, v90
    v_and_b32 v77, 0xffff0000, v90
    v_lshlrev_b32 v78, 16, v91
    v_and_b32 v79, 0xffff0000, v91
    v_add_f32 v9, v72, v73
    v_add_f32 v8, v74, v75
    v_add_f32 v10, v76, v77
    v_add_f32 v9, v9, v8
    v_add_f32 v8, v78, v79
    v_add_f32 v10, v10, v8
    v_add_f32 v9, v9, v10
    s_nop 1
    v_add_f32_dpp v9, v9, v9 quad_perm:[1,0,3,2] row_mask:0xf bank_mask:0xf
    s_nop 1
    v_add_f32_dpp v9, v9, v9 quad_perm:[2,3,0,1] row_mask:0xf bank_mask:0xf
    s_nop 1
    v_add_f32_dpp v9, v9, v9 row_ror:4 row_mask:0xf bank_mask:0xf
    s_nop 1
    v_add_f32_dpp v9, v9, v9 row_ror:8 row_mask:0xf bank_mask:0xf
    v_mov_b32 v8, v9
    s_nop 1
    v_permlane16_swap_b32 v9, v8
    v_add_f32 v9, v9, v8
    v_mov_b32 v8, v9
    s_nop 1
    v_permlane32_swap_b32 v9, v8
    v_add_f32 v9, v9, v8
    v_mul_f32 v9, 0x3b000000, v9
    v_sub_f32 v72, v72, v9
    v_sub_f32 v73, v73, v9
    v_sub_f32 v74, v74, v9
    v_sub_f32 v75, v75, v9
    v_sub_f32 v76, v76, v9
    v_sub_f32 v77, v77, v9
    v_sub_f32 v78, v78, v9
    v_sub_f32 v79, v79, v9
    v_mul_f32 v10, v72, v72
    v_fmac_f32 v10, v73, v73
    v_fmac_f32 v10, v74, v74
    v_fmac_f32 v10, v75, v75
    v_fmac_f32 v10, v76, v76
    v_fmac_f32 v10, v77, v77
    v_fmac_f32 v10, v78, v78
    v_fmac_f32 v10, v79, v79
    s_nop 1
    v_add_f32_dpp v10, v10, v10 quad_perm:[1,0,3,2] row_mask:0xf bank_mask:0xf
    s_nop 1
    v_add_f32_dpp v10, v10, v10 quad_perm:[2,3,0,1] row_mask:0xf bank_mask:0xf
    s_nop 1
    v_add_f32_dpp v10, v10, v10 row_ror:4 row_mask:0xf bank_mask:0xf
    s_nop 1
    v_add_f32_dpp v10, v10, v10 row_ror:8 row_mask:0xf bank_mask:0xf
    v_mov_b32 v8, v10
    s_nop 1
    v_permlane16_swap_b32 v10, v8
    v_add_f32 v10, v10, v8
    v_mov_b32 v8, v10
    s_nop 1
    v_permlane32_swap_b32 v10, v8
    v_add_f32 v10, v10, v8
    v_mov_b32 v8, 0x3727c5ac
    v_fmac_f32 v8, 0x3b000000, v10
    v_rsq_f32 v10, v8
    s_nop 0
    v_mul_f32 v72, v72, v10
    v_mul_f32 v73, v73, v10
    v_mul_f32 v74, v74, v10
    v_mul_f32 v75, v75, v10
    v_mul_f32 v76, v76, v10
    v_mul_f32 v77, v77, v10
    v_mul_f32 v78, v78, v10
    v_mul_f32 v79, v79, v10
    v_add_f32 v112, 1.0, v112
    v_fma_f32 v72, v72, v112, v104
    v_add_f32 v113, 1.0, v113
    v_fma_f32 v73, v73, v113, v105
    v_add_f32 v114, 1.0, v114
    v_fma_f32 v74, v74, v114, v106
    v_add_f32 v115, 1.0, v115
    v_fma_f32 v75, v75, v115, v107
    v_add_f32 v116, 1.0, v116
    v_fma_f32 v76, v76, v116, v108
    v_add_f32 v117, 1.0, v117
    v_fma_f32 v77, v77, v117, v109
    v_add_f32 v118, 1.0, v118
    v_fma_f32 v78, v78, v118, v110
    v_add_f32 v119, 1.0, v119
    v_fma_f32 v79, v79, v119, v111
    v_add_f32 v9, v72, v73
    v_add_f32 v8, v74, v75
    v_add_f32 v10, v76, v77
    v_add_f32 v9, v9, v8
    v_add_f32 v8, v78, v79
    v_add_f32 v10, v10, v8
    v_add_f32 v9, v9, v10
    s_nop 1
    v_add_f32_dpp v9, v9, v9 quad_perm:[1,0,3,2] row_mask:0xf bank_mask:0xf
    s_nop 1
    v_add_f32_dpp v9, v9, v9 quad_perm:[2,3,0,1] row_mask:0xf bank_mask:0xf
    s_nop 1
    v_add_f32_dpp v9, v9, v9 row_ror:4 row_mask:0xf bank_mask:0xf
    s_nop 1
    v_add_f32_dpp v9, v9, v9 row_ror:8 row_mask:0xf bank_mask:0xf
    v_mov_b32 v8, v9
    s_nop 1
    v_permlane16_swap_b32 v9, v8
    v_add_f32 v9, v9, v8
    v_mov_b32 v8, v9
    s_nop 1
    v_permlane32_swap_b32 v9, v8
    v_add_f32 v9, v9, v8
    v_mul_f32 v9, 0x3b000000, v9
    v_sub_f32 v72, v72, v9
    v_sub_f32 v73, v73, v9
    v_sub_f32 v74, v74, v9
    v_sub_f32 v75, v75, v9
    v_sub_f32 v76, v76, v9
    v_sub_f32 v77, v77, v9
    v_sub_f32 v78, v78, v9
    v_sub_f32 v79, v79, v9
    v_mul_f32 v10, v72, v72
    v_fmac_f32 v10, v73, v73
    v_fmac_f32 v10, v74, v74
    v_fmac_f32 v10, v75, v75
    v_fmac_f32 v10, v76, v76
    v_fmac_f32 v10, v77, v77
    v_fmac_f32 v10, v78, v78
    v_fmac_f32 v10, v79, v79
    s_nop 1
    v_add_f32_dpp v10, v10, v10 quad_perm:[1,0,3,2] row_mask:0xf bank_mask:0xf
    s_nop 1
    v_add_f32_dpp v10, v10, v10 quad_perm:[2,3,0,1] row_mask:0xf bank_mask:0xf
    s_nop 1
    v_add_f32_dpp v10, v10, v10 row_ror:4 row_mask:0xf bank_mask:0xf
    s_nop 1
    v_add_f32_dpp v10, v10, v10 row_ror:8 row_mask:0xf bank_mask:0xf
    v_mov_b32 v8, v10
    s_nop 1
    v_permlane16_swap_b32 v10, v8
    v_add_f32 v10, v10, v8
    v_mov_b32 v8, v10
    s_nop 1
    v_permlane32_swap_b32 v10, v8
    v_add_f32 v10, v10, v8
    v_mov_b32 v8, 0x3727c5ac
    v_fmac_f32 v8, 0x3b000000, v10
    v_rsq_f32 v10, v8
    s_nop 0
    v_mul_f32 v72, v72, v10
    v_mul_f32 v73, v73, v10
    v_mul_f32 v74, v74, v10
    v_mul_f32 v75, v75, v10
    v_mul_f32 v76, v76, v10
    v_mul_f32 v77, v77, v10
    v_mul_f32 v78, v78, v10
    v_mul_f32 v79, v79, v10
    v_cvt_pk_bf16_f32 v16, v72, v73
    v_cvt_pk_bf16_f32 v17, v74, v75
    v_cvt_pk_bf16_f32 v18, v76, v77
    v_cvt_pk_bf16_f32 v19, v78, v79
    s_add_u32 s44, s94, 7340032
    s_addc_u32 s45, s95, 0
    global_store_dwordx4 v11, v[16:19], s[44:45] sc1
    s_lshl_b32 s41, s14, 7
    s_add_u32 s41, s41, 20480
    s_waitcnt vmcnt(0)
    v_mov_b32 v16, s41
    v_mov_b32 v17, 1
    s_mov_b64 exec, 1
    global_atomic_add v16, v17, s[96:97] sc1
    s_mov_b64 exec, -1
redr_end_41:
    s_add_u32 s14, s14, 7
    s_cmp_lt_u32 s14, 64
    s_cbranch_scc1 L_att_loop
    v_lshrrev_b32 v8, 5, v0
    v_lshlrev_b32 v8, 5, v8
    s_lshr_b32 s40, s21, 1
    s_lshl_b32 s40, s40, 6
    s_lshl_b32 s41, s18, 7
    s_add_u32 s40, s40, s41
    v_add_u32 v8, s40, v8
    s_lshl_b32 s40, s20, 4
    v_add_u32 v7, s40, v8
    global_load_dwordx4 v[48:51], v7, s[10:11]
    v_bfe_u32 v10, v0, 2, 2
    v_lshlrev_b32 v10, 3, v10
    v_bfe_u32 v11, v0, 4, 1
    v_lshl_add_u32 v10, v11, 2, v10
    v_and_b32 v11, 3, v0
    v_add_u32 v10, v10, v11
    v_lshlrev_b32 v10, 4, v10
    v_lshl_add_u32 v10, v8, 5, v10
    s_and_b32 s40, s21, 1
    s_lshl_b32 s41, s19, 1
    s_add_u32 s40, s40, s41
    s_mul_i32 s40, s40, 114688
    s_lshl_b32 s41, s20, 9
    s_add_u32 s40, s40, s41
    v_add_u32 v13, s40, v10
L_g1_tail:
    s_cmp_lg_u32 s91, 0
    s_cbranch_scc1 g1w_43
    s_mov_b32 s98, 8000
g1p_44:
    v_and_b32 v64, 7, v0
    v_add_u32 v64, s15, v64
    v_cmp_gt_u32 s[40:41], 64, v64
    v_min_u32 v64, 63, v64
    v_lshlrev_b32 v64, 7, v64
    v_add_u32 v64, 20480, v64
    global_load_dword v65, v64, s[96:97] sc1
    s_waitcnt vmcnt(0)
    v_cmp_le_u32 vcc, 32, v65
    s_nop 0
    s_and_b32 s40, s40, vcc_lo
    s_and_b32 s40, s40, 0xff
    s_not_b32 s40, s40
    s_ff1_i32_b32 s42, s40
    s_cmp_lg_u32 s42, 0
    s_cbranch_scc1 g1go_45
    s_sleep 1
    s_sub_u32 s98, s98, 1
    s_cbranch_scc0 g1p_44
    s_branch L_err
g1go_45:
    v_mov_b32 v64, s42
    v_mov_b32 v65, 163776
    ds_write_b32 v65, v64
    s_waitcnt lgkmcnt(0)
g1w_43:
    s_barrier
    v_mov_b32 v65, 163776
    ds_read_b32 v64, v65
    s_waitcnt lgkmcnt(0)
    v_readfirstlane_b32 s42, v64
    s_barrier
    s_and_b32 s43, s42, 0xff
    s_cbranch_scc0 g1x_42
    s_mov_b32 s43, 0
    s_mov_b32 s44, s25
g1d_46:
    s_mov_b32 m0, s44
    s_nop 0
    global_load_lds_dwordx4 v124, s[22:23] sc1
    s_add_u32 s22, s22, s24
    s_addc_u32 s23, s23, 0
    s_add_u32 s44, s44, 8192
    s_add_u32 s43, s43, 1
    s_cmp_lt_u32 s43, s42
    s_cbranch_scc1 g1d_46
    s_waitcnt vmcnt(0)
    s_barrier
    v_mov_b32 v64, v125
    v_mov_b32 v65, v126
    s_mov_b32 s43, 0
g1m_47:
    ds_read_b64_tr_b16 v[68:69], v64 offset:0
    ds_read_b64_tr_b16 v[72:73], v65 offset:0
    ds_read_b64_tr_b16 v[70:71], v64 offset:512
    ds_read_b64_tr_b16 v[74:75], v65 offset:512
    v_add_u32 v64, 8192, v64
    v_add_u32 v65, 8192, v65
    s_waitcnt lgkmcnt(0)
    v_mfma_f32_32x32x16_bf16 a[64:79], v[68:71], v[72:75], a[64:79]
    s_add_u32 s43, s43, 1
    s_cmp_lt_u32 s43, s42
    s_cbranch_scc1 g1m_47
    s_add_u32 s15, s15, s42
g1x_42:
    s_cmp_lt_u32 s15, 64
    s_cbranch_scc1 L_g1_tail
    s_nop 11
    s_cmp_lg_u32 s20, 0
    s_cbranch_scc1 gk1_48
    v_accvgpr_read_b32 v16, a64
    v_accvgpr_read_b32 v24, a72
    v_accvgpr_read_b32 v17, a65
    v_accvgpr_read_b32 v25, a73
    v_accvgpr_read_b32 v18, a66
    v_accvgpr_read_b32 v26, a74
    v_accvgpr_read_b32 v19, a67
    v_accvgpr_read_b32 v27, a75
    v_accvgpr_read_b32 v20, a68
    v_accvgpr_read_b32 v28, a76
    v_accvgpr_read_b32 v21, a69
    v_accvgpr_read_b32 v29, a77
    v_accvgpr_read_b32 v22, a70
    v_accvgpr_read_b32 v30, a78
    v_accvgpr_read_b32 v23, a71
    v_accvgpr_read_b32 v31, a79
    s_branch gk2_49
gk1_48:
    v_accvgpr_read_b32 v16, a72
    v_accvgpr_read_b32 v24, a64
    v_accvgpr_read_b32 v17, a73
    v_accvgpr_read_b32 v25, a65
    v_accvgpr_read_b32 v18, a74
    v_accvgpr_read_b32 v26, a66
    v_accvgpr_read_b32 v19, a75
    v_accvgpr_read_b32 v27, a67
    v_accvgpr_read_b32 v20, a76
    v_accvgpr_read_b32 v28, a68
    v_accvgpr_read_b32 v21, a77
    v_accvgpr_read_b32 v29, a69
    v_accvgpr_read_b32 v22, a78
    v_accvgpr_read_b32 v30, a70
    v_accvgpr_read_b32 v23, a79
    v_accvgpr_read_b32 v31, a71
gk2_49:
    s_lshl_b32 s40, s91, 11
    v_lshlrev_b32 v6, 4, v0
    v_add_u32 v7, s40, v6
    ds_write_b128 v7, v[24:27]
    ds_write_b128 v7, v[28:31] offset:1024
    v_xor_b32 v7, 8192, v7
    s_waitcnt lgkmcnt(0)
    s_barrier
    ds_read_b128 v[32:35], v7
    ds_read_b128 v[36:39], v7 offset:1024
    s_mov_b32 s42, 0x3d372713
    s_mov_b32 s43, 0xc0135761
    s_waitcnt vmcnt(0) lgkmcnt(0)
    v_add_f32 v16, v16, v32
    v_lshlrev_b32 v32, 16, v48
    v_add_f32 v16, v16, v32
    v_add_f32 v17, v17, v33
    v_and_b32 v33, 0xffff0000, v48
    v_add_f32 v17, v17, v33
    v_add_f32 v18, v18, v34
    v_lshlrev_b32 v34, 16, v49
    v_add_f32 v18, v18, v34
    v_add_f32 v19, v19, v35
    v_and_b32 v35, 0xffff0000, v49
    v_add_f32 v19, v19, v35
    v_add_f32 v20, v20, v36
    v_lshlrev_b32 v36, 16, v50
    v_add_f32 v20, v20, v36
    v_add_f32 v21, v21, v37
    v_and_b32 v37, 0xffff0000, v50
    v_add_f32 v21, v21, v37
    v_add_f32 v22, v22, v38
    v_lshlrev_b32 v38, 16, v51
    v_add_f32 v22, v22, v38
    v_add_f32 v23, v23, v39
    v_and_b32 v39, 0xffff0000, v51
    v_add_f32 v23, v23, v39
    v_mul_f32 v32, v16, v16
    v_mul_f32 v33, v17, v17
    v_mul_f32 v34, v18, v18
    v_mul_f32 v35, v19, v19
    v_mul_f32 v36, v20, v20
    v_mul_f32 v37, v21, v21
    v_mul_f32 v38, v22, v22
    v_mul_f32 v39, v23, v23
    v_fma_f32 v32, v32, s42, 1.0
    v_fma_f32 v33, v33, s42, 1.0
    v_fma_f32 v34, v34, s42, 1.0
    v_fma_f32 v35, v35, s42, 1.0
    v_fma_f32 v36, v36, s42, 1.0
    v_fma_f32 v37, v37, s42, 1.0
    v_fma_f32 v38, v38, s42, 1.0
    v_fma_f32 v39, v39, s42, 1.0
    v_mul_f32 v32, v32, v16
    v_mul_f32 v33, v33, v17
    v_mul_f32 v34, v34, v18
    v_mul_f32 v35, v35, v19
    v_mul_f32 v36, v36, v20
    v_mul_f32 v37, v37, v21
    v_mul_f32 v38, v38, v22
    v_mul_f32 v39, v39, v23
    v_mul_f32 v32, s43, v32
    v_mul_f32 v33, s43, v33
    v_mul_f32 v34, s43, v34
    v_mul_f32 v35, s43, v35
    v_mul_f32 v36, s43, v36
    v_mul_f32 v37, s43, v37
    v_mul_f32 v38, s43, v38
    v_mul_f32 v39, s43, v39
    v_exp_f32 v32, v32
    v_exp_f32 v33, v33
    v_exp_f32 v34, v34
    v_exp_f32 v35, v35
    v_exp_f32 v36, v36
    v_exp_f32 v37, v37
    v_exp_f32 v38, v38
    v_exp_f32 v39, v39
    v_add_f32 v32, 1.0, v32
    v_add_f32 v33, 1.0, v33
    v_add_f32 v34, 1.0, v34
    v_add_f32 v35, 1.0, v35
    v_add_f32 v36, 1.0, v36
    v_add_f32 v37, 1.0, v37
    v_add_f32 v38, 1.0, v38
    v_add_f32 v39, 1.0, v39
    v_rcp_f32 v32, v32
    v_rcp_f32 v33, v33
    v_rcp_f32 v34, v34
    v_rcp_f32 v35, v35
    v_rcp_f32 v36, v36
    v_rcp_f32 v37, v37
    v_rcp_f32 v38, v38
    v_rcp_f32 v39, v39
    v_mul_f32 v16, v16, v32
    v_mul_f32 v17, v17, v33
    v_mul_f32 v18, v18, v34
    v_mul_f32 v19, v19, v35
    v_mul_f32 v20, v20, v36
    v_mul_f32 v21, v21, v37
    v_mul_f32 v22, v22, v38
    v_mul_f32 v23, v23, v39
    v_cvt_pk_bf16_f32 v48, v16, v17
    v_cvt_pk_bf16_f32 v49, v18, v19
    v_cvt_pk_bf16_f32 v50, v20, v21
    v_cvt_pk_bf16_f32 v51, v22, v23
    s_add_u32 s44, s94, 10485760
    s_addc_u32 s45, s95, 0
    global_store_dwordx4 v13, v[48:51], s[44:45] sc1
    s_lshl_b32 s26, s19, 7
    s_add_u32 s26, s26, 32768
    s_waitcnt vmcnt(0)
    s_barrier
    s_cmp_lg_u32 s91, 0
    s_cbranch_scc1 wgs_50
    v_mov_b32 v10, s26
    v_mov_b32 v11, 1
    s_mov_b64 exec, 1
    global_atomic_add v10, v11, s[96:97] sc1
    s_mov_b64 exec, -1
wgs_50:
L_g2:
    s_load_dwordx4 s[4:7], s[0:1], 80
    s_load_dwordx2 s[8:9], s[0:1], 112
    s_lshr_b32 s13, s90, 3
    s_and_b32 s14, s90, 7
    s_lshr_b32 s15, s91, 1
    s_and_b32 s16, s91, 1
    v_and_b32 v6, 7, v0
    v_bfe_u32 v7, v0, 4, 1
    v_lshlrev_b32 v7, 2, v7
    v_xor_b32 v6, v6, v7
    v_lshrrev_b32 v7, 3, v0
    v_mul_u32_u24 v7, 4096, v7
    v_lshl_add_u32 v1, v6, 4, v7
    v_lshrrev_b32 v6, 5, v0
    v_bfe_u32 v7, v0, 2, 2
    v_lshl_add_u32 v6, v6, 3, v7
    v_lshlrev_b32 v6, 7, v6
    v_bfe_u32 v7, v0, 3, 1
    v_lshl_add_u32 v6, v7, 6, v6
    v_bfe_u32 v7, v0, 4, 1
    v_lshl_add_u32 v6, v7, 5, v6
    v_and_b32 v7, 3, v0
    v_lshl_add_u32 v4, v7, 3, v6
    s_lshl_b32 s40, s15, 11
    v_add_u32 v4, s40, v4
    s_lshl_b32 s41, s14, 1
    s_add_u32 s40, s16, s41
    s_mul_i32 s40, s40, 114688
    s_lshl_b32 s41, s15, 10
    s_add_u32 s40, s40, s41
    v_lshlrev_b32 v2, 4, v0
    v_add_u32 v2, s40, v2
    s_add_u32 s22, s94, 10485760
    s_addc_u32 s23, s95, 0
    s_waitcnt lgkmcnt(0)
    s_lshl_b32 s40, s91, 17
    s_lshl_b32 s41, s13, 7
    s_add_u32 s40, s40, s41
    s_add_u32 s20, s4, s40
    s_addc_u32 s21, s5, 0
    s_lshl_b32 s24, s91, 12
    s_barrier
    s_add_u32 m0, s24, 0
    s_nop 0
    global_load_lds_dwordx4 v1, s[20:21]
    s_add_u32 s20, s20, 32768
    s_addc_u32 s21, s21, 0
    s_add_u32 m0, s24, 1024
    s_nop 0
    global_load_lds_dwordx4 v1, s[20:21]
    s_add_u32 s20, s20, 32768
    s_addc_u32 s21, s21, 0
    s_add_u32 m0, s24, 2048
    s_nop 0
    global_load_lds_dwordx4 v1, s[20:21]
    s_add_u32 s20, s20, 32768
    s_addc_u32 s21, s21, 0
    s_add_u32 m0, s24, 3072
    s_nop 0
    global_load_lds_dwordx4 v1, s[20:21]
    s_add_u32 s20, s20, 950272
    s_addc_u32 s21, s21, 0
    s_add_u32 m0, s24, 32768
    s_nop 0
    global_load_lds_dwordx4 v1, s[20:21]
    s_add_u32 s20, s20, 32768
    s_addc_u32 s21, s21, 0
    s_add_u32 m0, s24, 33792
    s_nop 0
    global_load_lds_dwordx4 v1, s[20:21]
    s_add_u32 s20, s20, 32768
    s_addc_u32 s21, s21, 0
    s_add_u32 m0, s24, 34816
    s_nop 0
    global_load_lds_dwordx4 v1, s[20:21]
    s_add_u32 s20, s20, 32768
    s_addc_u32 s21, s21, 0
    s_add_u32 m0, s24, 35840
    s_nop 0
    global_load_lds_dwordx4 v1, s[20:21]
    s_add_u32 s20, s20, 950272
    s_addc_u32 s21, s21, 0
    s_add_u32 m0, s24, 65536
    s_nop 0
    global_load_lds_dwordx4 v1, s[20:21]
    s_add_u32 s20, s20, 32768
    s_addc_u32 s21, s21, 0
    s_add_u32 m0, s24, 66560
    s_nop 0
    global_load_lds_dwordx4 v1, s[20:21]
    s_add_u32 s20, s20, 32768
    s_addc_u32 s21, s21, 0
    s_add_u32 m0, s24, 67584
    s_nop 0
    global_load_lds_dwordx4 v1, s[20:21]
    s_add_u32 s20, s20, 32768
    s_addc_u32 s21, s21, 0
    s_add_u32 m0, s24, 68608
    s_nop 0
    global_load_lds_dwordx4 v1, s[20:21]
    s_add_u32 s20, s20, 950272
    s_addc_u32 s21, s21, 0
    s_add_u32 m0, s24, 98304
    s_nop 0
    global_load_lds_dwordx4 v1, s[20:21]
    s_add_u32 s20, s20, 32768
    s_addc_u32 s21, s21, 0
    s_add_u32 m0, s24, 99328
    s_nop 0
    global_load_lds_dwordx4 v1, s[20:21]
    s_add_u32 s20, s20, 32768
    s_addc_u32 s21, s21, 0
    s_add_u32 m0, s24, 100352
    s_nop 0
    global_load_lds_dwordx4 v1, s[20:21]
    s_add_u32 s20, s20, 32768
    s_addc_u32 s21, s21, 0
    s_add_u32 m0, s24, 101376
    s_nop 0
    global_load_lds_dwordx4 v1, s[20:21]
    s_add_u32 s20, s20, 950272
    s_addc_u32 s21, s21, 0
    s_add_u32 m0, s24, 131072
    s_nop 0
    global_load_lds_dwordx4 v1, s[20:21]
    s_add_u32 s20, s20, 32768
    s_addc_u32 s21, s21, 0
    s_add_u32 m0, s24, 132096
    s_nop 0
    global_load_lds_dwordx4 v1, s[20:21]
    s_add_u32 s20, s20, 32768
    s_addc_u32 s21, s21, 0
    s_add_u32 m0, s24, 133120
    s_nop 0
    global_load_lds_dwordx4 v1, s[20:21]
    s_add_u32 s20, s20, 32768
    s_addc_u32 s21, s21, 0
    s_add_u32 m0, s24, 134144
    s_nop 0
    global_load_lds_dwordx4 v1, s[20:21]
    s_add_u32 s20, s20, 950272
    s_addc_u32 s21, s21, 0
    v_and_b32 v9, 31, v0
    s_lshr_b32 s40, s15, 1
    s_lshl_b32 s40, s40, 5
    s_lshl_b32 s41, s13, 6
    s_add_u32 s40, s40, s41
    v_add_u32 v9, s40, v9
    v_lshlrev_b32 v10, 1, v9
    global_load_ushort v108, v10, s[6:7]
    v_lshrrev_b32 v10, 5, v0
    v_lshlrev_b32 v10, 4, v10
    s_lshl_b32 s40, s16, 5
    s_lshl_b32 s41, s14, 6
    s_add_u32 s40, s40, s41
    s_and_b32 s41, s15, 1
    s_lshl_b32 s41, s41, 3
    s_add_u32 s40, s40, s41
    v_add_u32 v10, s40, v10
    v_lshlrev_b32 v9, 10, v9
    v_lshl_add_u32 v9, v10, 1, v9
    v_lshlrev_b32 v10, 2, v10
    s_add_u32 s44, s94, 10240
    s_addc_u32 s45, s95, 0
    global_load_dwordx4 v[100:103], v10, s[44:45] offset:0 sc1
    global_load_dwordx4 v[104:107], v10, s[44:45] offset:16 sc1
    s_lshl_b32 s26, s14, 7
    s_add_u32 s26, s26, 32768
    s_cmp_lg_u32 s91, 0
    s_cbranch_scc1 wgw_51
    v_mov_b32 v16, s26
    s_mov_b32 s98, 8000
wp_52:
    global_load_dword v17, v16, s[96:97] sc1
    s_waitcnt vmcnt(0)
    v_cmp_le_u32 vcc, 28, v17
    s_cbranch_vccnz wpok_53
    s_sleep 1
    s_sub_u32 s98, s98, 1
    s_cbranch_scc0 wp_52
    s_branch L_err
wpok_53:
wgw_51:
    s_barrier
    global_load_dwordx4 a[0:3], v2, s[22:23] sc1
    s_add_u32 s22, s22, 4096
    s_addc_u32 s23, s23, 0
    global_load_dwordx4 a[4:7], v2, s[22:23] sc1
    s_add_u32 s22, s22, 4096
    s_addc_u32 s23, s23, 0
    global_load_dwordx4 a[8:11], v2, s[22:23] sc1
    s_add_u32 s22, s22, 4096
    s_addc_u32 s23, s23, 0
    global_load_dwordx4 a[12:15], v2, s[22:23] sc1
    s_add_u32 s22, s22, 4096
    s_addc_u32 s23, s23, 0
    global_load_dwordx4 a[16:19], v2, s[22:23] sc1
    s_add_u32 s22, s22, 4096
    s_addc_u32 s23, s23, 0
    global_load_dwordx4 a[20:23], v2, s[22:23] sc1
    s_add_u32 s22, s22, 4096
    s_addc_u32 s23, s23, 0
    global_load_dwordx4 a[24:27], v2, s[22:23] sc1
    s_add_u32 s22, s22, 4096
    s_addc_u32 s23, s23, 0
    global_load_dwordx4 a[28:31], v2, s[22:23] sc1
    s_add_u32 s22, s22, 4096
    s_addc_u32 s23, s23, 0
    global_load_dwordx4 a[32:35], v2, s[22:23] sc1
    s_add_u32 s22, s22, 4096
    s_addc_u32 s23, s23, 0
    global_load_dwordx4 a[36:39], v2, s[22:23] sc1
    s_add_u32 s22, s22, 4096
    s_addc_u32 s23, s23, 0
    global_load_dwordx4 a[40:43], v2, s[22:23] sc1
    s_add_u32 s22, s22, 4096
    s_addc_u32 s23, s23, 0
    global_load_dwordx4 a[44:47], v2, s[22:23] sc1
    s_add_u32 s22, s22, 4096
    s_addc_u32 s23, s23, 0
    global_load_dwordx4 a[48:51], v2, s[22:23] sc1
    s_add_u32 s22, s22, 4096
    s_addc_u32 s23, s23, 0
    global_load_dwordx4 a[52:55], v2, s[22:23] sc1
    s_add_u32 s22, s22, 4096
    s_addc_u32 s23, s23, 0
    global_load_dwordx4 a[56:59], v2, s[22:23] sc1
    s_add_u32 s22, s22, 4096
    s_addc_u32 s23, s23, 0
    global_load_dwordx4 a[60:63], v2, s[22:23] sc1
    s_add_u32 s22, s22, 4096
    s_addc_u32 s23, s23, 0
    global_load_dwordx4 a[64:67], v2, s[22:23] sc1
    s_add_u32 s22, s22, 4096
    s_addc_u32 s23, s23, 0
    global_load_dwordx4 a[68:71], v2, s[22:23] sc1
    s_add_u32 s22, s22, 4096
    s_addc_u32 s23, s23, 0
    global_load_dwordx4 a[72:75], v2, s[22:23] sc1
    s_add_u32 s22, s22, 4096
    s_addc_u32 s23, s23, 0
    global_load_dwordx4 a[76:79], v2, s[22:23] sc1
    s_add_u32 s22, s22, 4096
    s_addc_u32 s23, s23, 0
    global_load_dwordx4 a[80:83], v2, s[22:23] sc1
    s_add_u32 s22, s22, 4096
    s_addc_u32 s23, s23, 0
    global_load_dwordx4 a[84:87], v2, s[22:23] sc1
    s_add_u32 s22, s22, 4096
    s_addc_u32 s23, s23, 0
    global_load_dwordx4 a[88:91], v2, s[22:23] sc1
    s_add_u32 s22, s22, 4096
    s_addc_u32 s23, s23, 0
    global_load_dwordx4 a[92:95], v2, s[22:23] sc1
    s_add_u32 s22, s22, 4096
    s_addc_u32 s23, s23, 0
    global_load_dwordx4 a[96:99], v2, s[22:23] sc1
    s_add_u32 s22, s22, 4096
    s_addc_u32 s23, s23, 0
    global_load_dwordx4 a[100:103], v2, s[22:23] sc1
    s_add_u32 s22, s22, 4096
    s_addc_u32 s23, s23, 0
    global_load_dwordx4 a[104:107], v2, s[22:23] sc1
    s_add_u32 s22, s22, 4096
    s_addc_u32 s23, s23, 0
    global_load_dwordx4 a[108:111], v2, s[22:23] sc1
    s_add_u32 s22, s22, 4096
    s_addc_u32 s23, s23, 0
    s_add_u32 s44, s94, 4194304
    s_addc_u32 s45, s95, 0
    global_load_dwordx4 v[96:99], v9, s[44:45] sc1
    v_xor_b32 v5, 64, v4
    s_waitcnt vmcnt(25)
    s_barrier
    v_add_u32 v6, 0, v4
    v_add_u32 v7, 0, v5
    ds_read_b64_tr_b16 v[48:49], v6 offset:0
    ds_read_b64_tr_b16 v[50:51], v6 offset:512
    ds_read_b64_tr_b16 v[52:53], v7 offset:0
    ds_read_b64_tr_b16 v[54:55], v7 offset:512
    ds_read_b64_tr_b16 v[56:57], v6 offset:8192
    ds_read_b64_tr_b16 v[58:59], v6 offset:8704
    ds_read_b64_tr_b16 v[60:61], v7 offset:8192
    ds_read_b64_tr_b16 v[62:63], v7 offset:8704
    ds_read_b64_tr_b16 v[64:65], v6 offset:16384
    ds_read_b64_tr_b16 v[66:67], v6 offset:16896
    ds_read_b64_tr_b16 v[68:69], v7 offset:16384
    ds_read_b64_tr_b16 v[70:71], v7 offset:16896
    ds_read_b64_tr_b16 v[72:73], v6 offset:24576
    ds_read_b64_tr_b16 v[74:75], v6 offset:25088
    ds_read_b64_tr_b16 v[76:77], v7 offset:24576
    ds_read_b64_tr_b16 v[78:79], v7 offset:25088
    s_waitcnt lgkmcnt(14)
    v_mfma_f32_32x32x16_bf16 v[16:31], a[0:3], v[48:51], 0
    s_waitcnt lgkmcnt(12)
    v_mfma_f32_32x32x16_bf16 v[32:47], a[0:3], v[52:55], 0
    s_waitcnt lgkmcnt(10)
    v_mfma_f32_32x32x16_bf16 v[16:31], a[4:7], v[56:59], v[16:31]
    s_waitcnt lgkmcnt(8)
    v_mfma_f32_32x32x16_bf16 v[32:47], a[4:7], v[60:63], v[32:47]
    s_waitcnt lgkmcnt(6)
    v_mfma_f32_32x32x16_bf16 v[16:31], a[8:11], v[64:67], v[16:31]
    s_waitcnt lgkmcnt(4)
    v_mfma_f32_32x32x16_bf16 v[32:47], a[8:11], v[68:71], v[32:47]
    s_waitcnt lgkmcnt(2)
    v_mfma_f32_32x32x16_bf16 v[16:31], a[12:15], v[72:75], v[16:31]
    s_waitcnt lgkmcnt(0)
    v_mfma_f32_32x32x16_bf16 v[32:47], a[12:15], v[76:79], v[32:47]
    s_barrier
    s_add_u32 m0, s24, 0
    s_nop 0
    global_load_lds_dwordx4 v1, s[20:21]
    s_add_u32 s20, s20, 32768
    s_addc_u32 s21, s21, 0
    s_add_u32 m0, s24, 1024
    s_nop 0
    global_load_lds_dwordx4 v1, s[20:21]
    s_add_u32 s20, s20, 32768
    s_addc_u32 s21, s21, 0
    s_add_u32 m0, s24, 2048
    s_nop 0
    global_load_lds_dwordx4 v1, s[20:21]
    s_add_u32 s20, s20, 32768
    s_addc_u32 s21, s21, 0
    s_add_u32 m0, s24, 3072
    s_nop 0
    global_load_lds_dwordx4 v1, s[20:21]
    s_add_u32 s20, s20, 950272
    s_addc_u32 s21, s21, 0
    s_waitcnt vmcnt(25)
    v_add_u32 v6, 32768, v4
    v_add_u32 v7, 32768, v5
    ds_read_b64_tr_b16 v[48:49], v6 offset:0
    ds_read_b64_tr_b16 v[50:51], v6 offset:512
    ds_read_b64_tr_b16 v[52:53], v7 offset:0
    ds_read_b64_tr_b16 v[54:55], v7 offset:512
    ds_read_b64_tr_b16 v[56:57], v6 offset:8192
    ds_read_b64_tr_b16 v[58:59], v6 offset:8704
    ds_read_b64_tr_b16 v[60:61], v7 offset:8192
    ds_read_b64_tr_b16 v[62:63], v7 offset:8704
    ds_read_b64_tr_b16 v[64:65], v6 offset:16384
    ds_read_b64_tr_b16 v[66:67], v6 offset:16896
    ds_read_b64_tr_b16 v[68:69], v7 offset:16384
    ds_read_b64_tr_b16 v[70:71], v7 offset:16896
    ds_read_b64_tr_b16 v[72:73], v6 offset:24576
    ds_read_b64_tr_b16 v[74:75], v6 offset:25088
    ds_read_b64_tr_b16 v[76:77], v7 offset:24576
    ds_read_b64_tr_b16 v[78:79], v7 offset:25088
    s_waitcnt lgkmcnt(14)
    v_mfma_f32_32x32x16_bf16 v[16:31], a[16:19], v[48:51], v[16:31]
    s_waitcnt lgkmcnt(12)
    v_mfma_f32_32x32x16_bf16 v[32:47], a[16:19], v[52:55], v[32:47]
    s_waitcnt lgkmcnt(10)
    v_mfma_f32_32x32x16_bf16 v[16:31], a[20:23], v[56:59], v[16:31]
    s_waitcnt lgkmcnt(8)
    v_mfma_f32_32x32x16_bf16 v[32:47], a[20:23], v[60:63], v[32:47]
    s_waitcnt lgkmcnt(6)
    v_mfma_f32_32x32x16_bf16 v[16:31], a[24:27], v[64:67], v[16:31]
    s_waitcnt lgkmcnt(4)
    v_mfma_f32_32x32x16_bf16 v[32:47], a[24:27], v[68:71], v[32:47]
    s_waitcnt lgkmcnt(2)
    v_mfma_f32_32x32x16_bf16 v[16:31], a[28:31], v[72:75], v[16:31]
    s_waitcnt lgkmcnt(0)
    v_mfma_f32_32x32x16_bf16 v[32:47], a[28:31], v[76:79], v[32:47]
    s_barrier
    s_add_u32 m0, s24, 32768
    s_nop 0
    global_load_lds_dwordx4 v1, s[20:21]
    s_add_u32 s20, s20, 32768
    s_addc_u32 s21, s21, 0
    s_add_u32 m0, s24, 33792
    s_nop 0
    global_load_lds_dwordx4 v1, s[20:21]
    s_add_u32 s20, s20, 32768
    s_addc_u32 s21, s21, 0
    s_add_u32 m0, s24, 34816
    s_nop 0
    global_load_lds_dwordx4 v1, s[20:21]
    s_add_u32 s20, s20, 32768
    s_addc_u32 s21, s21, 0
    s_add_u32 m0, s24, 35840
    s_nop 0
    global_load_lds_dwordx4 v1, s[20:21]
    s_add_u32 s20, s20, 950272
    s_addc_u32 s21, s21, 0
    s_waitcnt vmcnt(25)
    v_add_u32 v6, 65536, v4
    v_add_u32 v7, 65536, v5
    ds_read_b64_tr_b16 v[48:49], v6 offset:0
    ds_read_b64_tr_b16 v[50:51], v6 offset:512
    ds_read_b64_tr_b16 v[52:53], v7 offset:0
    ds_read_b64_tr_b16 v[54:55], v7 offset:512
    ds_read_b64_tr_b16 v[56:57], v6 offset:8192
    ds_read_b64_tr_b16 v[58:59], v6 offset:8704
    ds_read_b64_tr_b16 v[60:61], v7 offset:8192
    ds_read_b64_tr_b16 v[62:63], v7 offset:8704
    ds_read_b64_tr_b16 v[64:65], v6 offset:16384
    ds_read_b64_tr_b16 v[66:67], v6 offset:16896
    ds_read_b64_tr_b16 v[68:69], v7 offset:16384
    ds_read_b64_tr_b16 v[70:71], v7 offset:16896
    ds_read_b64_tr_b16 v[72:73], v6 offset:24576
    ds_read_b64_tr_b16 v[74:75], v6 offset:25088
    ds_read_b64_tr_b16 v[76:77], v7 offset:24576
    ds_read_b64_tr_b16 v[78:79], v7 offset:25088
    s_waitcnt lgkmcnt(14)
    v_mfma_f32_32x32x16_bf16 v[16:31], a[32:35], v[48:51], v[16:31]
    s_waitcnt lgkmcnt(12)
    v_mfma_f32_32x32x16_bf16 v[32:47], a[32:35], v[52:55], v[32:47]
    s_waitcnt lgkmcnt(10)
    v_mfma_f32_32x32x16_bf16 v[16:31], a[36:39], v[56:59], v[16:31]
    s_waitcnt lgkmcnt(8)
    v_mfma_f32_32x32x16_bf16 v[32:47], a[36:39], v[60:63], v[32:47]
    s_waitcnt lgkmcnt(6)
    v_mfma_f32_32x32x16_bf16 v[16:31], a[40:43], v[64:67], v[16:31]
    s_waitcnt lgkmcnt(4)
    v_mfma_f32_32x32x16_bf16 v[32:47], a[40:43], v[68:71], v[32:47]
    s_waitcnt lgkmcnt(2)
    v_mfma_f32_32x32x16_bf16 v[16:31], a[44:47], v[72:75], v[16:31]
    s_waitcnt lgkmcnt(0)
    v_mfma_f32_32x32x16_bf16 v[32:47], a[44:47], v[76:79], v[32:47]
    s_waitcnt vmcnt(21)
    v_add_u32 v6, 98304, v4
    v_add_u32 v7, 98304, v5
    ds_read_b64_tr_b16 v[48:49], v6 offset:0
    ds_read_b64_tr_b16 v[50:51], v6 offset:512
    ds_read_b64_tr_b16 v[52:53], v7 offset:0
    ds_read_b64_tr_b16 v[54:55], v7 offset:512
    ds_read_b64_tr_b16 v[56:57], v6 offset:8192
    ds_read_b64_tr_b16 v[58:59], v6 offset:8704
    ds_read_b64_tr_b16 v[60:61], v7 offset:8192
    ds_read_b64_tr_b16 v[62:63], v7 offset:8704
    ds_read_b64_tr_b16 v[64:65], v6 offset:16384
    ds_read_b64_tr_b16 v[66:67], v6 offset:16896
    ds_read_b64_tr_b16 v[68:69], v7 offset:16384
    ds_read_b64_tr_b16 v[70:71], v7 offset:16896
    ds_read_b64_tr_b16 v[72:73], v6 offset:24576
    ds_read_b64_tr_b16 v[74:75], v6 offset:25088
    ds_read_b64_tr_b16 v[76:77], v7 offset:24576
    ds_read_b64_tr_b16 v[78:79], v7 offset:25088
    s_waitcnt lgkmcnt(14)
    v_mfma_f32_32x32x16_bf16 v[16:31], a[48:51], v[48:51], v[16:31]
    s_waitcnt lgkmcnt(12)
    v_mfma_f32_32x32x16_bf16 v[32:47], a[48:51], v[52:55], v[32:47]
    s_waitcnt lgkmcnt(10)
    v_mfma_f32_32x32x16_bf16 v[16:31], a[52:55], v[56:59], v[16:31]
    s_waitcnt lgkmcnt(8)
    v_mfma_f32_32x32x16_bf16 v[32:47], a[52:55], v[60:63], v[32:47]
    s_waitcnt lgkmcnt(6)
    v_mfma_f32_32x32x16_bf16 v[16:31], a[56:59], v[64:67], v[16:31]
    s_waitcnt lgkmcnt(4)
    v_mfma_f32_32x32x16_bf16 v[32:47], a[56:59], v[68:71], v[32:47]
    s_waitcnt lgkmcnt(2)
    v_mfma_f32_32x32x16_bf16 v[16:31], a[60:63], v[72:75], v[16:31]
    s_waitcnt lgkmcnt(0)
    v_mfma_f32_32x32x16_bf16 v[32:47], a[60:63], v[76:79], v[32:47]
    s_waitcnt vmcnt(17)
    v_add_u32 v6, 131072, v4
    v_add_u32 v7, 131072, v5
    ds_read_b64_tr_b16 v[48:49], v6 offset:0
    ds_read_b64_tr_b16 v[50:51], v6 offset:512
    ds_read_b64_tr_b16 v[52:53], v7 offset:0
    ds_read_b64_tr_b16 v[54:55], v7 offset:512
    ds_read_b64_tr_b16 v[56:57], v6 offset:8192
    ds_read_b64_tr_b16 v[58:59], v6 offset:8704
    ds_read_b64_tr_b16 v[60:61], v7 offset:8192
    ds_read_b64_tr_b16 v[62:63], v7 offset:8704
    ds_read_b64_tr_b16 v[64:65], v6 offset:16384
    ds_read_b64_tr_b16 v[66:67], v6 offset:16896
    ds_read_b64_tr_b16 v[68:69], v7 offset:16384
    ds_read_b64_tr_b16 v[70:71], v7 offset:16896
    ds_read_b64_tr_b16 v[72:73], v6 offset:24576
    ds_read_b64_tr_b16 v[74:75], v6 offset:25088
    ds_read_b64_tr_b16 v[76:77], v7 offset:24576
    ds_read_b64_tr_b16 v[78:79], v7 offset:25088
    s_waitcnt lgkmcnt(14)
    v_mfma_f32_32x32x16_bf16 v[16:31], a[64:67], v[48:51], v[16:31]
    s_waitcnt lgkmcnt(12)
    v_mfma_f32_32x32x16_bf16 v[32:47], a[64:67], v[52:55], v[32:47]
    s_waitcnt lgkmcnt(10)
    v_mfma_f32_32x32x16_bf16 v[16:31], a[68:71], v[56:59], v[16:31]
    s_waitcnt lgkmcnt(8)
    v_mfma_f32_32x32x16_bf16 v[32:47], a[68:71], v[60:63], v[32:47]
    s_waitcnt lgkmcnt(6)
    v_mfma_f32_32x32x16_bf16 v[16:31], a[72:75], v[64:67], v[16:31]
    s_waitcnt lgkmcnt(4)
    v_mfma_f32_32x32x16_bf16 v[32:47], a[72:75], v[68:71], v[32:47]
    s_waitcnt lgkmcnt(2)
    v_mfma_f32_32x32x16_bf16 v[16:31], a[76:79], v[72:75], v[16:31]
    s_waitcnt lgkmcnt(0)
    v_mfma_f32_32x32x16_bf16 v[32:47], a[76:79], v[76:79], v[32:47]
    s_waitcnt vmcnt(4)
    s_barrier
    v_add_u32 v6, 0, v4
    v_add_u32 v7, 0, v5
    ds_read_b64_tr_b16 v[48:49], v6 offset:0
    ds_read_b64_tr_b16 v[50:51], v6 offset:512
    ds_read_b64_tr_b16 v[52:53], v7 offset:0
    ds_read_b64_tr_b16 v[54:55], v7 offset:512
    ds_read_b64_tr_b16 v[56:57], v6 offset:8192
    ds_read_b64_tr_b16 v[58:59], v6 offset:8704
    ds_read_b64_tr_b16 v[60:61], v7 offset:8192
    ds_read_b64_tr_b16 v[62:63], v7 offset:8704
    ds_read_b64_tr_b16 v[64:65], v6 offset:16384
    ds_read_b64_tr_b16 v[66:67], v6 offset:16896
    ds_read_b64_tr_b16 v[68:69], v7 offset:16384
    ds_read_b64_tr_b16 v[70:71], v7 offset:16896
    ds_read_b64_tr_b16 v[72:73], v6 offset:24576
    ds_read_b64_tr_b16 v[74:75], v6 offset:25088
    ds_read_b64_tr_b16 v[76:77], v7 offset:24576
    ds_read_b64_tr_b16 v[78:79], v7 offset:25088
    s_waitcnt lgkmcnt(14)
    v_mfma_f32_32x32x16_bf16 v[16:31], a[80:83], v[48:51], v[16:31]
    s_waitcnt lgkmcnt(12)
    v_mfma_f32_32x32x16_bf16 v[32:47], a[80:83], v[52:55], v[32:47]
    s_waitcnt lgkmcnt(10)
    v_mfma_f32_32x32x16_bf16 v[16:31], a[84:87], v[56:59], v[16:31]
    s_waitcnt lgkmcnt(8)
    v_mfma_f32_32x32x16_bf16 v[32:47], a[84:87], v[60:63], v[32:47]
    s_waitcnt lgkmcnt(6)
    v_mfma_f32_32x32x16_bf16 v[16:31], a[88:91], v[64:67], v[16:31]
    s_waitcnt lgkmcnt(4)
    v_mfma_f32_32x32x16_bf16 v[32:47], a[88:91], v[68:71], v[32:47]
    s_waitcnt lgkmcnt(2)
    v_mfma_f32_32x32x16_bf16 v[16:31], a[92:95], v[72:75], v[16:31]
    s_waitcnt lgkmcnt(0)
    v_mfma_f32_32x32x16_bf16 v[32:47], a[92:95], v[76:79], v[32:47]
    s_waitcnt vmcnt(0)
    s_barrier
    v_add_u32 v6, 32768, v4
    v_add_u32 v7, 32768, v5
    ds_read_b64_tr_b16 v[48:49], v6 offset:0
    ds_read_b64_tr_b16 v[50:51], v6 offset:512
    ds_read_b64_tr_b16 v[52:53], v7 offset:0
    ds_read_b64_tr_b16 v[54:55], v7 offset:512
    ds_read_b64_tr_b16 v[56:57], v6 offset:8192
    ds_read_b64_tr_b16 v[58:59], v6 offset:8704
    ds_read_b64_tr_b16 v[60:61], v7 offset:8192
    ds_read_b64_tr_b16 v[62:63], v7 offset:8704
    ds_read_b64_tr_b16 v[64:65], v6 offset:16384
    ds_read_b64_tr_b16 v[66:67], v6 offset:16896
    ds_read_b64_tr_b16 v[68:69], v7 offset:16384
    ds_read_b64_tr_b16 v[70:71], v7 offset:16896
    ds_read_b64_tr_b16 v[72:73], v6 offset:24576
    ds_read_b64_tr_b16 v[74:75], v6 offset:25088
    ds_read_b64_tr_b16 v[76:77], v7 offset:24576
    ds_read_b64_tr_b16 v[78:79], v7 offset:25088
    s_waitcnt lgkmcnt(14)
    v_mfma_f32_32x32x16_bf16 v[16:31], a[96:99], v[48:51], v[16:31]
    s_waitcnt lgkmcnt(12)
    v_mfma_f32_32x32x16_bf16 v[32:47], a[96:99], v[52:55], v[32:47]
    s_waitcnt lgkmcnt(10)
    v_mfma_f32_32x32x16_bf16 v[16:31], a[100:103], v[56:59], v[16:31]
    s_waitcnt lgkmcnt(8)
    v_mfma_f32_32x32x16_bf16 v[32:47], a[100:103], v[60:63], v[32:47]
    s_waitcnt lgkmcnt(6)
    v_mfma_f32_32x32x16_bf16 v[16:31], a[104:107], v[64:67], v[16:31]
    s_waitcnt lgkmcnt(4)
    v_mfma_f32_32x32x16_bf16 v[32:47], a[104:107], v[68:71], v[32:47]
    s_waitcnt lgkmcnt(2)
    v_mfma_f32_32x32x16_bf16 v[16:31], a[108:111], v[72:75], v[16:31]
    s_waitcnt lgkmcnt(0)
    v_mfma_f32_32x32x16_bf16 v[32:47], a[108:111], v[76:79], v[32:47]
    s_barrier
    s_lshl_b32 s40, s16, 15
    s_lshl_b32 s41, s15, 11
    s_add_u32 s40, s40, s41
    v_lshlrev_b32 v6, 4, v0
    v_add_u32 v7, s40, v6
    s_nop 3
    ds_write_b128 v7, v[16:19] offset:0
    ds_write_b128 v7, v[20:23] offset:1024
    ds_write_b128 v7, v[24:27] offset:8192
    ds_write_b128 v7, v[28:31] offset:9216
    ds_write_b128 v7, v[32:35] offset:16384
    ds_write_b128 v7, v[36:39] offset:17408
    ds_write_b128 v7, v[40:43] offset:24576
    ds_write_b128 v7, v[44:47] offset:25600
    s_lshl_b32 s40, s16, 15
    s_lshl_b32 s41, s15, 13
    s_add_u32 s40, s40, s41
    v_add_u32 v7, s40, v6
    s_waitcnt lgkmcnt(0)
    s_barrier
    ds_read_b128 v[48:51], v7 offset:0
    ds_read_b128 v[52:55], v7 offset:1024
    ds_read_b128 v[56:59], v7 offset:2048
    ds_read_b128 v[60:63], v7 offset:3072
    ds_read_b128 v[64:67], v7 offset:4096
    ds_read_b128 v[68:71], v7 offset:5120
    ds_read_b128 v[72:75], v7 offset:6144
    ds_read_b128 v[76:79], v7 offset:7168
    s_waitcnt vmcnt(0) lgkmcnt(0)
    v_lshlrev_b32 v108, 16, v108
    v_add_f32 v48, v48, v56
    v_add_f32 v64, v64, v72
    v_add_f32 v48, v48, v64
    v_add_f32 v48, v48, v108
    v_lshlrev_b32 v6, 16, v96
    v_fma_f32 v48, v48, v100, v6
    v_add_f32 v49, v49, v57
    v_add_f32 v65, v65, v73
    v_add_f32 v49, v49, v65
    v_add_f32 v49, v49, v108
    v_and_b32 v6, 0xffff0000, v96
    v_fma_f32 v49, v49, v101, v6
    v_add_f32 v50, v50, v58
    v_add_f32 v66, v66, v74
    v_add_f32 v50, v50, v66
    v_add_f32 v50, v50, v108
    v_lshlrev_b32 v6, 16, v97
    v_fma_f32 v50, v50, v102, v6
    v_add_f32 v51, v51, v59
    v_add_f32 v67, v67, v75
    v_add_f32 v51, v51, v67
    v_add_f32 v51, v51, v108
    v_and_b32 v6, 0xffff0000, v97
    v_fma_f32 v51, v51, v103, v6
    v_add_f32 v52, v52, v60
    v_add_f32 v68, v68, v76
    v_add_f32 v52, v52, v68
    v_add_f32 v52, v52, v108
    v_lshlrev_b32 v6, 16, v98
    v_fma_f32 v52, v52, v104, v6
    v_add_f32 v53, v53, v61
    v_add_f32 v69, v69, v77
    v_add_f32 v53, v53, v69
    v_add_f32 v53, v53, v108
    v_and_b32 v6, 0xffff0000, v98
    v_fma_f32 v53, v53, v105, v6
    v_add_f32 v54, v54, v62
    v_add_f32 v70, v70, v78
    v_add_f32 v54, v54, v70
    v_add_f32 v54, v54, v108
    v_lshlrev_b32 v6, 16, v99
    v_fma_f32 v54, v54, v106, v6
    v_add_f32 v55, v55, v63
    v_add_f32 v71, v71, v79
    v_add_f32 v55, v55, v71
    v_add_f32 v55, v55, v108
    v_and_b32 v6, 0xffff0000, v99
    v_fma_f32 v55, v55, v107, v6
    v_cvt_pk_bf16_f32 v96, v48, v49
    v_cvt_pk_bf16_f32 v97, v50, v51
    v_cvt_pk_bf16_f32 v98, v52, v53
    v_cvt_pk_bf16_f32 v99, v54, v55
    global_store_dwordx4 v9, v[96:99], s[8:9]
    s_branch L_end
L_head:
    s_load_dwordx4 s[4:7], s[0:1], 16
    s_load_dwordx4 s[8:11], s[0:1], 32
    s_load_dwordx2 s[12:13], s[0:1], 8
    s_mov_b64 s[14:15], s[92:93]
    s_mov_b64 s[16:17], s[94:95]
    s_mov_b32 s18, s90
    s_mov_b32 s60, s91
    s_add_u32 s90, s90, 224
    s_waitcnt lgkmcnt(0)
    s_barrier
    s_and_b32 s19, s60, 3
    s_lshr_b32 s47, s60, 2
    v_mov_b32 v40, v0
    v_lshlrev_b32 v1, 4, v40
    v_and_b32 v41, 15, v40
    v_lshrrev_b32 v42, 4, v40
    v_lshlrev_b32 v43, 1, v42
    v_xor_b32 v43, v43, v41
    v_lshlrev_b32 v43, 4, v43
    v_lshl_add_u32 v43, v42, 13, v43
    v_xor_b32 v60, 0x80, v43
    s_lshl_b32 s22, s18, 8
    s_lshl_b32 s23, s19, 19
    s_add_u32 s22, s22, s23
    s_lshl_b32 s23, s47, 18
    s_add_u32 s22, s22, s23
    s_add_u32 s4, s4, s22
    s_addc_u32 s5, s5, 0
    s_add_u32 s6, s6, s22
    s_addc_u32 s7, s7, 0
    s_add_u32 s8, s8, s22
    s_addc_u32 s9, s9, 0
    s_lshl_b32 s22, s18, 17
    s_lshl_b32 s23, s19, 14
    s_add_u32 s22, s22, s23
    s_lshl_b32 s23, s47, 13
    s_add_u32 s22, s22, s23
    s_add_u32 s10, s10, s22
    s_addc_u32 s11, s11, 0
    s_lshl_b32 s24, s19, 15
    s_add_u32 s24, s24, 32768
    v_add_u32 v5, s24, v1
    s_lshl_b32 s23, s47, 13
    s_add_u32 s24, s24, s23
    v_add_u32 v5, s23, v5
    v_lshrrev_b32 v52, 3, v40
    v_lshlrev_b32 v52, 10, v52
    v_bfe_u32 v53, v40, 1, 2
    v_lshl_add_u32 v52, v53, 1, v52
    v_and_b32 v53, 1, v40
    v_lshl_add_u32 v52, v53, 4, v52
    s_lshl_b32 s21, s18, 5
    v_add_u32 v52, s21, v52
    global_load_ushort v54, v52, s[12:13]
    global_load_ushort v55, v52, s[12:13] offset:8
    s_add_u32 s22, s4, 0
    s_addc_u32 s23, s5, 0
    s_add_u32 m0, s24, 0
    s_nop 0
    global_load_lds_dwordx4 v43, s[22:23]
    s_add_u32 s22, s4, 32768
    s_addc_u32 s23, s5, 0
    s_add_u32 m0, s24, 1024
    s_nop 0
    global_load_lds_dwordx4 v60, s[22:23]
    s_add_u32 s22, s4, 65536
    s_addc_u32 s23, s5, 0
    s_add_u32 m0, s24, 2048
    s_nop 0
    global_load_lds_dwordx4 v43, s[22:23]
    s_add_u32 s22, s4, 98304
    s_addc_u32 s23, s5, 0
    s_add_u32 m0, s24, 3072
    s_nop 0
    global_load_lds_dwordx4 v60, s[22:23]
    s_add_u32 s22, s4, 131072
    s_addc_u32 s23, s5, 0
    s_add_u32 m0, s24, 4096
    s_nop 0
    global_load_lds_dwordx4 v43, s[22:23]
    s_add_u32 s22, s4, 163840
    s_addc_u32 s23, s5, 0
    s_add_u32 m0, s24, 5120
    s_nop 0
    global_load_lds_dwordx4 v60, s[22:23]
    s_add_u32 s22, s4, 196608
    s_addc_u32 s23, s5, 0
    s_add_u32 m0, s24, 6144
    s_nop 0
    global_load_lds_dwordx4 v43, s[22:23]
    s_add_u32 s22, s4, 229376
    s_addc_u32 s23, s5, 0
    s_add_u32 m0, s24, 7168
    s_nop 0
    global_load_lds_dwordx4 v60, s[22:23]
    s_add_u32 s22, s4, 2097152
    s_addc_u32 s23, s5, 0
    s_add_u32 m0, s24, 16384
    s_nop 0
    global_load_lds_dwordx4 v43, s[22:23]
    s_add_u32 s22, s4, 2129920
    s_addc_u32 s23, s5, 0
    s_add_u32 m0, s24, 17408
    s_nop 0
    global_load_lds_dwordx4 v60, s[22:23]
    s_add_u32 s22, s4, 2162688
    s_addc_u32 s23, s5, 0
    s_add_u32 m0, s24, 18432
    s_nop 0
    global_load_lds_dwordx4 v43, s[22:23]
    s_add_u32 s22, s4, 2195456
    s_addc_u32 s23, s5, 0
    s_add_u32 m0, s24, 19456
    s_nop 0
    global_load_lds_dwordx4 v60, s[22:23]
    s_add_u32 s22, s4, 2228224
    s_addc_u32 s23, s5, 0
    s_add_u32 m0, s24, 20480
    s_nop 0
    global_load_lds_dwordx4 v43, s[22:23]
    s_add_u32 s22, s4, 2260992
    s_addc_u32 s23, s5, 0
    s_add_u32 m0, s24, 21504
    s_nop 0
    global_load_lds_dwordx4 v60, s[22:23]
    s_add_u32 s22, s4, 2293760
    s_addc_u32 s23, s5, 0
    s_add_u32 m0, s24, 22528
    s_nop 0
    global_load_lds_dwordx4 v43, s[22:23]
    s_add_u32 s22, s4, 2326528
    s_addc_u32 s23, s5, 0
    s_add_u32 m0, s24, 23552
    s_nop 0
    global_load_lds_dwordx4 v60, s[22:23]
    v_lshrrev_b32 v50, 2, v41
    v_and_b32 v51, 3, v41
    v_lshrrev_b32 v52, 1, v42
    v_lshlrev_b32 v52, 4, v52
    v_and_b32 v53, 1, v42
    v_add_u32 v52, v52, v53
    v_and_b32 v53, 1, v50
    v_lshl_add_u32 v52, v53, 2, v52
    v_lshrrev_b32 v53, 1, v50
    v_lshl_add_u32 v52, v53, 1, v52
    v_and_b32 v53, 7, v52
    v_lshlrev_b32 v53, 5, v53
    s_lshl_b32 s21, s19, 6
    v_xor_b32 v53, s21, v53
    v_lshlrev_b32 v52, 8, v52
    v_lshl_add_u32 v52, v51, 3, v52
    v_add3_u32 v52, v52, v53, 0
    v_add_u32 v52, 32768, v52
    s_xor_b32 s21, s19, 0
    s_lshl_b32 s21, s21, 15
    v_add_u32 v44, s21, v52
    s_xor_b32 s21, s19, 1
    s_lshl_b32 s21, s21, 15
    v_add_u32 v45, s21, v52
    s_xor_b32 s21, s19, 2
    s_lshl_b32 s21, s21, 15
    v_add_u32 v46, s21, v52
    s_xor_b32 s21, s19, 3
    s_lshl_b32 s21, s21, 15
    v_add_u32 v47, s21, v52
    v_lshrrev_b32 v52, 1, v42
    v_lshlrev_b32 v52, 3, v52
    v_lshrrev_b32 v53, 1, v50
    v_lshl_add_u32 v52, v53, 2, v52
    v_and_b32 v53, 1, v50
    v_add_u32 v52, v52, v53
    v_lshlrev_b32 v52, 10, v52
    v_and_b32 v53, 1, v42
    v_lshl_add_u32 v52, v53, 15, v52
    v_lshl_add_u32 v52, v51, 5, v52
    s_lshl_b32 s21, s19, 8
    s_lshl_b32 s25, s47, 7
    s_add_u32 s21, s21, s25
    s_add_u32 s21, s21, 32768
    v_add_u32 v48, s21, v52
    v_add_u32 v49, 0x10000, v48
    v_and_b32 v52, 1, v40
    v_mul_u32_u24 v52, 0xAAAA, v52
    v_add_u32 v0, 0x4444, v52
    v_mul_u32_u24 v52, 576, v42
    v_lshl_add_u32 v52, v41, 2, v52
    s_mul_i32 s25, s47, 2304
    s_lshl_b32 s21, s19, 6
    s_add_u32 s21, s21, s25
    s_add_u32 s21, s21, 24576
    v_add_u32 v2, s21, v52
    v_lshrrev_b32 v52, 1, v41
    v_mul_u32_u24 v52, 288, v52
    v_lshl_add_u32 v52, v42, 5, v52
    v_and_b32 v53, 1, v41
    v_lshl_add_u32 v52, v53, 4, v52
    v_add_u32 v3, 29184, v52
    v_lshlrev_b32 v52, 13, v50
    v_lshl_add_u32 v52, v42, 10, v52
    v_lshl_add_u32 v52, v51, 4, v52
    s_lshl_b32 s21, s19, 16
    s_lshl_b32 s25, s47, 15
    s_add_u32 s21, s21, s25
    s_lshr_b32 s25, s18, 4
    s_lshl_b32 s25, s25, 12
    s_add_u32 s21, s21, s25
    s_and_b32 s25, s18, 15
    s_lshl_b32 s25, s25, 6
    s_add_u32 s21, s21, s25
    v_add_u32 v4, s21, v52
    v_lshlrev_b32 v52, 4, v41
    s_lshl_b32 s21, s19, 9
    s_lshl_b32 s25, s47, 8
    s_add_u32 s21, s21, s25
    v_add_u32 v6, s21, v52
    s_lshl_b32 s21, s19, 2
    v_mov_b32 v7, s21
    v_and_b32 v52, 31, v40
    v_lshlrev_b32 v52, 6, v52
    v_lshrrev_b32 v53, 5, v40
    v_lshl_add_u32 v13, v53, 24, v52
    s_cmp_lg_u32 s47, 0
    s_cbranch_scc1 su_b_54
    v_and_b32 v52, 7, v41
    v_mul_u32_u24 v52, 288, v52
    v_lshl_add_u32 v52, v42, 4, v52
    v_add_u32 v8, 24576, v52
    s_lshl_b32 s21, s19, 6
    s_add_u32 s21, s21, 29184
    v_add_u32 v10, s21, v52
    v_and_b32 v53, 1, v41
    v_lshl_add_u32 v53, v50, 1, v53
    v_mul_u32_u24 v52, 288, v53
    v_lshl_add_u32 v52, v42, 4, v52
    v_add_u32 v9, 26880, v52
    v_lshlrev_b32 v15, 2, v51
    v_lshl_add_u32 v6, v42, 2, v6
    s_branch su_e_55
su_b_54:
    s_lshl_b32 s21, s19, 10
    v_add_u32 v8, s21, v1
    v_lshlrev_b32 v52, 5, v42
    v_lshl_add_u32 v52, v51, 3, v52
    v_and_b32 v52, 63, v52
    s_lshl_b32 s21, s19, 6
    s_lshl_b32 s25, s18, 8
    s_add_u32 s21, s21, s25
    v_add_u32 v9, s21, v52
    v_bfe_u32 v52, v40, 2, 3
    v_lshlrev_b32 v52, 8, v52
    v_lshl_add_u32 v52, v51, 4, v52
    s_lshl_b32 s21, s19, 6
    v_add_u32 v10, s21, v52
    v_and_b32 v52, 31, v40
    v_lshlrev_b32 v52, 6, v52
    v_lshrrev_b32 v53, 5, v40
    v_lshl_add_u32 v15, v53, 24, v52
su_e_55:
    s_add_u32 s50, s16, 67108864
    s_addc_u32 s51, s17, 0
    s_add_u32 s52, s16, 68157440
    s_addc_u32 s53, s17, 0
    s_lshl_b32 s21, s18, 13
    s_lshl_b32 s25, s19, 11
    s_add_u32 s25, s25, s21
    s_add_u32 s34, s16, 33554432
    s_addc_u32 s35, s17, 0
    s_add_u32 s34, s34, s25
    s_addc_u32 s35, s35, 0
    s_add_u32 s36, s16, 50331648
    s_addc_u32 s37, s17, 0
    s_add_u32 s36, s36, s25
    s_addc_u32 s37, s37, 0
    s_lshl_b32 s21, s18, 11
    s_add_u32 s38, s16, 69206016
    s_addc_u32 s39, s17, 0
    s_add_u32 s38, s38, s21
    s_addc_u32 s39, s39, 0
    s_add_u32 s40, s16, 73400320
    s_addc_u32 s41, s17, 0
    s_add_u32 s40, s40, s21
    s_addc_u32 s41, s41, 0
    s_add_u32 s44, s16, 77594624
    s_addc_u32 s45, s17, 0
    s_mov_b32 s46, 0x3e0293ee
    s_mov_b32 s58, 0x000f000f
    s_mov_b32 s59, 0
    s_mov_b64 s[32:33], s[52:53]
    s_mov_b64 s[42:43], s[50:51]
    v_mov_b32 v52, 0
    v_lshlrev_b32 v53, 2, v41
    ds_write_b32 v53, v52 offset:32528
    v_mov_b32 v16, -1
    v_mov_b32 v17, -1
    v_mov_b32 v18, -1
    v_mov_b32 v19, -1
    s_lshl_b32 s21, s18, 13
    s_lshl_b32 s25, s60, 10
    s_add_u32 s21, s21, s25
    v_add_u32 v52, s21, v1
    global_store_dwordx4 v52, v[16:19], s[52:53] sc1
    v_add_u32 v52, 0x40000, v52
    global_store_dwordx4 v52, v[16:19], s[52:53] sc1
    v_add_u32 v52, 0x40000, v52
    global_store_dwordx4 v52, v[16:19], s[52:53] sc1
    v_add_u32 v52, 0x40000, v52
    global_store_dwordx4 v52, v[16:19], s[52:53] sc1
    v_add_u32 v52, 0x40000, v52
    s_waitcnt vmcnt(20)
    v_lshl_or_b32 v54, v55, 16, v54
    v_min_u32 v54, 0xfffffffe, v54
    s_cmp_eq_u32 s19, 0
    s_cselect_b64 vcc, -1, 0
    v_cndmask_b32 v54, -1, v54, vcc
    s_lshl_b32 s21, s19, 13
    s_lshl_b32 s25, s18, 8
    s_add_u32 s21, s21, s25
    v_lshlrev_b32 v52, 2, v40
    v_add_u32 v52, s21, v52
    global_store_dword v52, v54, s[50:51] sc1
    s_lshl_b32 s21, s47, 5
    v_xor_b32 v56, s21, v44
    v_xor_b32 v57, s21, v45
    v_xor_b32 v58, s21, v46
    v_xor_b32 v59, s21, v47
    v_xor_b32 v20, 32, v44
    v_xor_b32 v21, 32, v45
    v_xor_b32 v22, 32, v46
    v_xor_b32 v23, 32, v47
    s_waitcnt vmcnt(13)
    s_barrier
    s_cmp_lg_u32 s47, 0
    s_cbranch_scc1 su_skip_56
    ds_read_b64_tr_b16 a[0:1], v44 offset:0
    ds_read_b64_tr_b16 a[2:3], v44 offset:2048
    ds_read_b64_tr_b16 a[4:5], v44 offset:8192
    ds_read_b64_tr_b16 a[6:7], v44 offset:10240
    ds_read_b64_tr_b16 a[8:9], v45 offset:0
    ds_read_b64_tr_b16 a[10:11], v45 offset:2048
    ds_read_b64_tr_b16 a[12:13], v45 offset:8192
    ds_read_b64_tr_b16 a[14:15], v45 offset:10240
    s_waitcnt lgkmcnt(4)
    ds_read_b64_tr_b16 a[16:17], v46 offset:0
    ds_read_b64_tr_b16 a[18:19], v46 offset:2048
    ds_read_b64_tr_b16 a[20:21], v46 offset:8192
    ds_read_b64_tr_b16 a[22:23], v46 offset:10240
    ds_read_b64_tr_b16 a[24:25], v47 offset:0
    ds_read_b64_tr_b16 a[26:27], v47 offset:2048
    ds_read_b64_tr_b16 a[28:29], v47 offset:8192
    ds_read_b64_tr_b16 a[30:31], v47 offset:10240
    s_waitcnt lgkmcnt(4)
    ds_read_b64_tr_b16 a[64:65], v20 offset:0
    ds_read_b64_tr_b16 a[66:67], v20 offset:2048
    ds_read_b64_tr_b16 a[68:69], v20 offset:8192
    ds_read_b64_tr_b16 a[70:71], v20 offset:10240
    ds_read_b64_tr_b16 a[72:73], v21 offset:0
    ds_read_b64_tr_b16 a[74:75], v21 offset:2048
    ds_read_b64_tr_b16 a[76:77], v21 offset:8192
    ds_read_b64_tr_b16 a[78:79], v21 offset:10240
    s_waitcnt lgkmcnt(4)
    ds_read_b64_tr_b16 a[80:81], v22 offset:0
    ds_read_b64_tr_b16 a[82:83], v22 offset:2048
    ds_read_b64_tr_b16 a[84:85], v22 offset:8192
    ds_read_b64_tr_b16 a[86:87], v22 offset:10240
    ds_read_b64_tr_b16 a[88:89], v23 offset:0
    ds_read_b64_tr_b16 a[90:91], v23 offset:2048
    ds_read_b64_tr_b16 a[92:93], v23 offset:8192
    ds_read_b64_tr_b16 a[94:95], v23 offset:10240
    s_waitcnt lgkmcnt(4)
su_skip_56:
    s_waitcnt lgkmcnt(0)
    s_barrier
    s_add_u32 s22, s6, 0
    s_addc_u32 s23, s7, 0
    s_add_u32 m0, s24, 0
    s_nop 0
    global_load_lds_dwordx4 v43, s[22:23]
    s_add_u32 s22, s6, 32768
    s_addc_u32 s23, s7, 0
    s_add_u32 m0, s24, 1024
    s_nop 0
    global_load_lds_dwordx4 v60, s[22:23]
    s_add_u32 s22, s6, 65536
    s_addc_u32 s23, s7, 0
    s_add_u32 m0, s24, 2048
    s_nop 0
    global_load_lds_dwordx4 v43, s[22:23]
    s_add_u32 s22, s6, 98304
    s_addc_u32 s23, s7, 0
    s_add_u32 m0, s24, 3072
    s_nop 0
    global_load_lds_dwordx4 v60, s[22:23]
    s_add_u32 s22, s6, 131072
    s_addc_u32 s23, s7, 0
    s_add_u32 m0, s24, 4096
    s_nop 0
    global_load_lds_dwordx4 v43, s[22:23]
    s_add_u32 s22, s6, 163840
    s_addc_u32 s23, s7, 0
    s_add_u32 m0, s24, 5120
    s_nop 0
    global_load_lds_dwordx4 v60, s[22:23]
    s_add_u32 s22, s6, 196608
    s_addc_u32 s23, s7, 0
    s_add_u32 m0, s24, 6144
    s_nop 0
    global_load_lds_dwordx4 v43, s[22:23]
    s_add_u32 s22, s6, 229376
    s_addc_u32 s23, s7, 0
    s_add_u32 m0, s24, 7168
    s_nop 0
    global_load_lds_dwordx4 v60, s[22:23]
    s_waitcnt vmcnt(8)
    s_barrier
    s_cmp_lg_u32 s47, 0
    s_cbranch_scc1 su_skip_57
    ds_read_b64_tr_b16 a[32:33], v44 offset:16384
    ds_read_b64_tr_b16 a[34:35], v44 offset:18432
    ds_read_b64_tr_b16 a[36:37], v44 offset:24576
    ds_read_b64_tr_b16 a[38:39], v44 offset:26624
    ds_read_b64_tr_b16 a[40:41], v45 offset:16384
    ds_read_b64_tr_b16 a[42:43], v45 offset:18432
    ds_read_b64_tr_b16 a[44:45], v45 offset:24576
    ds_read_b64_tr_b16 a[46:47], v45 offset:26624
    s_waitcnt lgkmcnt(4)
    ds_read_b64_tr_b16 a[48:49], v46 offset:16384
    ds_read_b64_tr_b16 a[50:51], v46 offset:18432
    ds_read_b64_tr_b16 a[52:53], v46 offset:24576
    ds_read_b64_tr_b16 a[54:55], v46 offset:26624
    ds_read_b64_tr_b16 a[56:57], v47 offset:16384
    ds_read_b64_tr_b16 a[58:59], v47 offset:18432
    ds_read_b64_tr_b16 a[60:61], v47 offset:24576
    ds_read_b64_tr_b16 a[62:63], v47 offset:26624
    s_waitcnt lgkmcnt(4)
    ds_read_b64_tr_b16 a[96:97], v20 offset:16384
    ds_read_b64_tr_b16 a[98:99], v20 offset:18432
    ds_read_b64_tr_b16 a[100:101], v20 offset:24576
    ds_read_b64_tr_b16 a[102:103], v20 offset:26624
    ds_read_b64_tr_b16 a[104:105], v21 offset:16384
    ds_read_b64_tr_b16 a[106:107], v21 offset:18432
    ds_read_b64_tr_b16 a[108:109], v21 offset:24576
    ds_read_b64_tr_b16 a[110:111], v21 offset:26624
    s_waitcnt lgkmcnt(4)
    ds_read_b64_tr_b16 a[112:113], v22 offset:16384
    ds_read_b64_tr_b16 a[114:115], v22 offset:18432
    ds_read_b64_tr_b16 a[116:117], v22 offset:24576
    ds_read_b64_tr_b16 a[118:119], v22 offset:26624
    ds_read_b64_tr_b16 a[120:121], v23 offset:16384
    ds_read_b64_tr_b16 a[122:123], v23 offset:18432
    ds_read_b64_tr_b16 a[124:125], v23 offset:24576
    ds_read_b64_tr_b16 a[126:127], v23 offset:26624
    s_waitcnt lgkmcnt(4)
su_skip_57:
    s_waitcnt lgkmcnt(0)
    s_barrier
    s_add_u32 s22, s6, 2097152
    s_addc_u32 s23, s7, 0
    s_add_u32 m0, s24, 16384
    s_nop 0
    global_load_lds_dwordx4 v43, s[22:23]
    s_add_u32 s22, s6, 2129920
    s_addc_u32 s23, s7, 0
    s_add_u32 m0, s24, 17408
    s_nop 0
    global_load_lds_dwordx4 v60, s[22:23]
    s_add_u32 s22, s6, 2162688
    s_addc_u32 s23, s7, 0
    s_add_u32 m0, s24, 18432
    s_nop 0
    global_load_lds_dwordx4 v43, s[22:23]
    s_add_u32 s22, s6, 2195456
    s_addc_u32 s23, s7, 0
    s_add_u32 m0, s24, 19456
    s_nop 0
    global_load_lds_dwordx4 v60, s[22:23]
    s_add_u32 s22, s6, 2228224
    s_addc_u32 s23, s7, 0
    s_add_u32 m0, s24, 20480
    s_nop 0
    global_load_lds_dwordx4 v43, s[22:23]
    s_add_u32 s22, s6, 2260992
    s_addc_u32 s23, s7, 0
    s_add_u32 m0, s24, 21504
    s_nop 0
    global_load_lds_dwordx4 v60, s[22:23]
    s_add_u32 s22, s6, 2293760
    s_addc_u32 s23, s7, 0
    s_add_u32 m0, s24, 22528
    s_nop 0
    global_load_lds_dwordx4 v43, s[22:23]
    s_add_u32 s22, s6, 2326528
    s_addc_u32 s23, s7, 0
    s_add_u32 m0, s24, 23552
    s_nop 0
    global_load_lds_dwordx4 v60, s[22:23]
    s_waitcnt vmcnt(8)
    s_barrier
    s_cmp_lg_u32 s47, 1
    s_cbranch_scc1 su_skip_58
    ds_read_b64_tr_b16 a[0:1], v44 offset:0
    ds_read_b64_tr_b16 a[2:3], v44 offset:2048
    ds_read_b64_tr_b16 a[4:5], v44 offset:8192
    ds_read_b64_tr_b16 a[6:7], v44 offset:10240
    ds_read_b64_tr_b16 a[8:9], v45 offset:0
    ds_read_b64_tr_b16 a[10:11], v45 offset:2048
    ds_read_b64_tr_b16 a[12:13], v45 offset:8192
    ds_read_b64_tr_b16 a[14:15], v45 offset:10240
    s_waitcnt lgkmcnt(4)
    ds_read_b64_tr_b16 a[16:17], v46 offset:0
    ds_read_b64_tr_b16 a[18:19], v46 offset:2048
    ds_read_b64_tr_b16 a[20:21], v46 offset:8192
    ds_read_b64_tr_b16 a[22:23], v46 offset:10240
    ds_read_b64_tr_b16 a[24:25], v47 offset:0
    ds_read_b64_tr_b16 a[26:27], v47 offset:2048
    ds_read_b64_tr_b16 a[28:29], v47 offset:8192
    ds_read_b64_tr_b16 a[30:31], v47 offset:10240
    s_waitcnt lgkmcnt(4)
    ds_read_b64_tr_b16 a[64:65], v20 offset:0
    ds_read_b64_tr_b16 a[66:67], v20 offset:2048
    ds_read_b64_tr_b16 a[68:69], v20 offset:8192
    ds_read_b64_tr_b16 a[70:71], v20 offset:10240
    ds_read_b64_tr_b16 a[72:73], v21 offset:0
    ds_read_b64_tr_b16 a[74:75], v21 offset:2048
    ds_read_b64_tr_b16 a[76:77], v21 offset:8192
    ds_read_b64_tr_b16 a[78:79], v21 offset:10240
    s_waitcnt lgkmcnt(4)
    ds_read_b64_tr_b16 a[80:81], v22 offset:0
    ds_read_b64_tr_b16 a[82:83], v22 offset:2048
    ds_read_b64_tr_b16 a[84:85], v22 offset:8192
    ds_read_b64_tr_b16 a[86:87], v22 offset:10240
    ds_read_b64_tr_b16 a[88:89], v23 offset:0
    ds_read_b64_tr_b16 a[90:91], v23 offset:2048
    ds_read_b64_tr_b16 a[92:93], v23 offset:8192
    ds_read_b64_tr_b16 a[94:95], v23 offset:10240
    s_waitcnt lgkmcnt(4)
su_skip_58:
    s_waitcnt lgkmcnt(0)
    s_barrier
    s_add_u32 s22, s8, 0
    s_addc_u32 s23, s9, 0
    s_add_u32 m0, s24, 0
    s_nop 0
    global_load_lds_dwordx4 v43, s[22:23]
    s_add_u32 s22, s8, 32768
    s_addc_u32 s23, s9, 0
    s_add_u32 m0, s24, 1024
    s_nop 0
    global_load_lds_dwordx4 v60, s[22:23]
    s_add_u32 s22, s8, 65536
    s_addc_u32 s23, s9, 0
    s_add_u32 m0, s24, 2048
    s_nop 0
    global_load_lds_dwordx4 v43, s[22:23]
    s_add_u32 s22, s8, 98304
    s_addc_u32 s23, s9, 0
    s_add_u32 m0, s24, 3072
    s_nop 0
    global_load_lds_dwordx4 v60, s[22:23]
    s_add_u32 s22, s8, 131072
    s_addc_u32 s23, s9, 0
    s_add_u32 m0, s24, 4096
    s_nop 0
    global_load_lds_dwordx4 v43, s[22:23]
    s_add_u32 s22, s8, 163840
    s_addc_u32 s23, s9, 0
    s_add_u32 m0, s24, 5120
    s_nop 0
    global_load_lds_dwordx4 v60, s[22:23]
    s_add_u32 s22, s8, 196608
    s_addc_u32 s23, s9, 0
    s_add_u32 m0, s24, 6144
    s_nop 0
    global_load_lds_dwordx4 v43, s[22:23]
    s_add_u32 s22, s8, 229376
    s_addc_u32 s23, s9, 0
    s_add_u32 m0, s24, 7168
    s_nop 0
    global_load_lds_dwordx4 v60, s[22:23]
    s_cmp_lg_u32 s60, 0
    s_cbranch_scc1 arr_59
    v_mov_b32 v11, 36
    v_mov_b32 v12, 1
    s_mov_b64 exec, 1
    global_atomic_add v11, v12, s[14:15] sc1
    s_mov_b64 exec, -1
arr_59:
    s_waitcnt vmcnt(8)
    s_barrier
    s_cmp_lg_u32 s47, 1
    s_cbranch_scc1 su_skip_60
    ds_read_b64_tr_b16 a[32:33], v44 offset:16384
    ds_read_b64_tr_b16 a[34:35], v44 offset:18432
    ds_read_b64_tr_b16 a[36:37], v44 offset:24576
    ds_read_b64_tr_b16 a[38:39], v44 offset:26624
    ds_read_b64_tr_b16 a[40:41], v45 offset:16384
    ds_read_b64_tr_b16 a[42:43], v45 offset:18432
    ds_read_b64_tr_b16 a[44:45], v45 offset:24576
    ds_read_b64_tr_b16 a[46:47], v45 offset:26624
    s_waitcnt lgkmcnt(4)
    ds_read_b64_tr_b16 a[48:49], v46 offset:16384
    ds_read_b64_tr_b16 a[50:51], v46 offset:18432
    ds_read_b64_tr_b16 a[52:53], v46 offset:24576
    ds_read_b64_tr_b16 a[54:55], v46 offset:26624
    ds_read_b64_tr_b16 a[56:57], v47 offset:16384
    ds_read_b64_tr_b16 a[58:59], v47 offset:18432
    ds_read_b64_tr_b16 a[60:61], v47 offset:24576
    ds_read_b64_tr_b16 a[62:63], v47 offset:26624
    s_waitcnt lgkmcnt(4)
    ds_read_b64_tr_b16 a[96:97], v20 offset:16384
    ds_read_b64_tr_b16 a[98:99], v20 offset:18432
    ds_read_b64_tr_b16 a[100:101], v20 offset:24576
    ds_read_b64_tr_b16 a[102:103], v20 offset:26624
    ds_read_b64_tr_b16 a[104:105], v21 offset:16384
    ds_read_b64_tr_b16 a[106:107], v21 offset:18432
    ds_read_b64_tr_b16 a[108:109], v21 offset:24576
    ds_read_b64_tr_b16 a[110:111], v21 offset:26624
    s_waitcnt lgkmcnt(4)
    ds_read_b64_tr_b16 a[112:113], v22 offset:16384
    ds_read_b64_tr_b16 a[114:115], v22 offset:18432
    ds_read_b64_tr_b16 a[116:117], v22 offset:24576
    ds_read_b64_tr_b16 a[118:119], v22 offset:26624
    ds_read_b64_tr_b16 a[120:121], v23 offset:16384
    ds_read_b64_tr_b16 a[122:123], v23 offset:18432
    ds_read_b64_tr_b16 a[124:125], v23 offset:24576
    ds_read_b64_tr_b16 a[126:127], v23 offset:26624
    s_waitcnt lgkmcnt(4)
su_skip_60:
    s_waitcnt lgkmcnt(0)
    s_barrier
    s_add_u32 s22, s8, 2097152
    s_addc_u32 s23, s9, 0
    s_add_u32 m0, s24, 16384
    s_nop 0
    global_load_lds_dwordx4 v43, s[22:23]
    s_add_u32 s22, s8, 2129920
    s_addc_u32 s23, s9, 0
    s_add_u32 m0, s24, 17408
    s_nop 0
    global_load_lds_dwordx4 v60, s[22:23]
    s_add_u32 s22, s8, 2162688
    s_addc_u32 s23, s9, 0
    s_add_u32 m0, s24, 18432
    s_nop 0
    global_load_lds_dwordx4 v43, s[22:23]
    s_add_u32 s22, s8, 2195456
    s_addc_u32 s23, s9, 0
    s_add_u32 m0, s24, 19456
    s_nop 0
    global_load_lds_dwordx4 v60, s[22:23]
    s_add_u32 s22, s8, 2228224
    s_addc_u32 s23, s9, 0
    s_add_u32 m0, s24, 20480
    s_nop 0
    global_load_lds_dwordx4 v43, s[22:23]
    s_add_u32 s22, s8, 2260992
    s_addc_u32 s23, s9, 0
    s_add_u32 m0, s24, 21504
    s_nop 0
    global_load_lds_dwordx4 v60, s[22:23]
    s_add_u32 s22, s8, 2293760
    s_addc_u32 s23, s9, 0
    s_add_u32 m0, s24, 22528
    s_nop 0
    global_load_lds_dwordx4 v43, s[22:23]
    s_add_u32 s22, s8, 2326528
    s_addc_u32 s23, s9, 0
    s_add_u32 m0, s24, 23552
    s_nop 0
    global_load_lds_dwordx4 v60, s[22:23]
    s_waitcnt vmcnt(8)
    s_barrier
    ds_read_b64_tr_b16 v[64:65], v56 offset:0
    ds_read_b64_tr_b16 v[66:67], v56 offset:2048
    ds_read_b64_tr_b16 v[68:69], v56 offset:8192
    ds_read_b64_tr_b16 v[70:71], v56 offset:10240
    ds_read_b64_tr_b16 v[72:73], v57 offset:0
    ds_read_b64_tr_b16 v[74:75], v57 offset:2048
    ds_read_b64_tr_b16 v[76:77], v57 offset:8192
    ds_read_b64_tr_b16 v[78:79], v57 offset:10240
    s_waitcnt lgkmcnt(4)
    ds_read_b64_tr_b16 v[80:81], v58 offset:0
    ds_read_b64_tr_b16 v[82:83], v58 offset:2048
    ds_read_b64_tr_b16 v[84:85], v58 offset:8192
    ds_read_b64_tr_b16 v[86:87], v58 offset:10240
    ds_read_b64_tr_b16 v[88:89], v59 offset:0
    ds_read_b64_tr_b16 v[90:91], v59 offset:2048
    ds_read_b64_tr_b16 v[92:93], v59 offset:8192
    ds_read_b64_tr_b16 v[94:95], v59 offset:10240
    s_waitcnt lgkmcnt(4)
    s_waitcnt lgkmcnt(0)
    s_barrier
    s_add_u32 s22, s10, 0
    s_addc_u32 s23, s11, 0
    s_add_u32 m0, s24, 0
    s_nop 0
    global_load_lds_dwordx4 v1, s[22:23]
    s_add_u32 s22, s10, 1024
    s_addc_u32 s23, s11, 0
    s_add_u32 m0, s24, 1024
    s_nop 0
    global_load_lds_dwordx4 v1, s[22:23]
    s_add_u32 s22, s10, 2048
    s_addc_u32 s23, s11, 0
    s_add_u32 m0, s24, 2048
    s_nop 0
    global_load_lds_dwordx4 v1, s[22:23]
    s_add_u32 s22, s10, 3072
    s_addc_u32 s23, s11, 0
    s_add_u32 m0, s24, 3072
    s_nop 0
    global_load_lds_dwordx4 v1, s[22:23]
    s_add_u32 s22, s10, 4096
    s_addc_u32 s23, s11, 0
    s_add_u32 m0, s24, 4096
    s_nop 0
    global_load_lds_dwordx4 v1, s[22:23]
    s_add_u32 s22, s10, 5120
    s_addc_u32 s23, s11, 0
    s_add_u32 m0, s24, 5120
    s_nop 0
    global_load_lds_dwordx4 v1, s[22:23]
    s_add_u32 s22, s10, 6144
    s_addc_u32 s23, s11, 0
    s_add_u32 m0, s24, 6144
    s_nop 0
    global_load_lds_dwordx4 v1, s[22:23]
    s_add_u32 s22, s10, 7168
    s_addc_u32 s23, s11, 0
    s_add_u32 m0, s24, 7168
    s_nop 0
    global_load_lds_dwordx4 v1, s[22:23]
    s_waitcnt vmcnt(8)
    s_barrier
    ds_read_b64_tr_b16 v[96:97], v56 offset:16384
    ds_read_b64_tr_b16 v[98:99], v56 offset:18432
    ds_read_b64_tr_b16 v[100:101], v56 offset:24576
    ds_read_b64_tr_b16 v[102:103], v56 offset:26624
    ds_read_b64_tr_b16 v[104:105], v57 offset:16384
    ds_read_b64_tr_b16 v[106:107], v57 offset:18432
    ds_read_b64_tr_b16 v[108:109], v57 offset:24576
    ds_read_b64_tr_b16 v[110:111], v57 offset:26624
    s_waitcnt lgkmcnt(4)
    ds_read_b64_tr_b16 v[112:113], v58 offset:16384
    ds_read_b64_tr_b16 v[114:115], v58 offset:18432
    ds_read_b64_tr_b16 v[116:117], v58 offset:24576
    ds_read_b64_tr_b16 v[118:119], v58 offset:26624
    ds_read_b64_tr_b16 v[120:121], v59 offset:16384
    ds_read_b64_tr_b16 v[122:123], v59 offset:18432
    ds_read_b64_tr_b16 v[124:125], v59 offset:24576
    ds_read_b64_tr_b16 v[126:127], v59 offset:26624
    s_waitcnt lgkmcnt(4)
    s_waitcnt lgkmcnt(0)
    s_barrier
    s_add_u32 s22, s10, 65536
    s_addc_u32 s23, s11, 0
    s_add_u32 m0, s24, 16384
    s_nop 0
    global_load_lds_dwordx4 v1, s[22:23]
    s_add_u32 s22, s10, 66560
    s_addc_u32 s23, s11, 0
    s_add_u32 m0, s24, 17408
    s_nop 0
    global_load_lds_dwordx4 v1, s[22:23]
    s_add_u32 s22, s10, 67584
    s_addc_u32 s23, s11, 0
    s_add_u32 m0, s24, 18432
    s_nop 0
    global_load_lds_dwordx4 v1, s[22:23]
    s_add_u32 s22, s10, 68608
    s_addc_u32 s23, s11, 0
    s_add_u32 m0, s24, 19456
    s_nop 0
    global_load_lds_dwordx4 v1, s[22:23]
    s_add_u32 s22, s10, 69632
    s_addc_u32 s23, s11, 0
    s_add_u32 m0, s24, 20480
    s_nop 0
    global_load_lds_dwordx4 v1, s[22:23]
    s_add_u32 s22, s10, 70656
    s_addc_u32 s23, s11, 0
    s_add_u32 m0, s24, 21504
    s_nop 0
    global_load_lds_dwordx4 v1, s[22:23]
    s_add_u32 s22, s10, 71680
    s_addc_u32 s23, s11, 0
    s_add_u32 m0, s24, 22528
    s_nop 0
    global_load_lds_dwordx4 v1, s[22:23]
    s_add_u32 s22, s10, 72704
    s_addc_u32 s23, s11, 0
    s_add_u32 m0, s24, 23552
    s_nop 0
    global_load_lds_dwordx4 v1, s[22:23]
    s_waitcnt vmcnt(8)
    s_barrier
    ds_read_b64_tr_b16 v[16:17], v48 offset:0
    ds_read_b64_tr_b16 v[18:19], v48 offset:2048
    ds_read_b64_tr_b16 v[20:21], v49 offset:0
    ds_read_b64_tr_b16 v[22:23], v49 offset:2048
    ds_read_b64_tr_b16 v[24:25], v48 offset:8
    ds_read_b64_tr_b16 v[26:27], v48 offset:2056
    ds_read_b64_tr_b16 v[28:29], v49 offset:8
    ds_read_b64_tr_b16 v[30:31], v49 offset:2056
    s_waitcnt lgkmcnt(4)
    ds_read_b64_tr_b16 v[32:33], v48 offset:16
    ds_read_b64_tr_b16 v[34:35], v48 offset:2064
    ds_read_b64_tr_b16 v[36:37], v49 offset:16
    ds_read_b64_tr_b16 v[38:39], v49 offset:2064
    ds_read_b64_tr_b16 v[52:53], v48 offset:24
    ds_read_b64_tr_b16 v[54:55], v48 offset:2072
    ds_read_b64_tr_b16 v[56:57], v49 offset:24
    ds_read_b64_tr_b16 v[58:59], v49 offset:2072
    s_waitcnt lgkmcnt(4)
    s_waitcnt lgkmcnt(0)
    s_barrier
    s_cmp_lg_u32 s47, 0
    s_cbranch_scc1 su_ob_61
    ds_write_b128 v5, v[16:19] offset:0
    ds_write_b128 v5, v[20:23] offset:1024
    ds_write_b128 v5, v[24:27] offset:2048
    ds_write_b128 v5, v[28:31] offset:3072
    ds_write_b128 v5, v[32:35] offset:4096
    ds_write_b128 v5, v[36:39] offset:5120
    ds_write_b128 v5, v[52:55] offset:6144
    ds_write_b128 v5, v[56:59] offset:7168
    s_branch su_oe_62
su_ob_61:
    ds_write_b128 v5, v[64:67] offset:0
    ds_write_b128 v5, v[68:71] offset:1024
    ds_write_b128 v5, v[72:75] offset:2048
    ds_write_b128 v5, v[76:79] offset:3072
    ds_write_b128 v5, v[80:83] offset:4096
    ds_write_b128 v5, v[84:87] offset:5120
    ds_write_b128 v5, v[88:91] offset:6144
    ds_write_b128 v5, v[92:95] offset:7168
    s_waitcnt lgkmcnt(0)
    v_mov_b64 v[64:65], v[16:17]
    v_mov_b64 v[66:67], v[18:19]
    v_mov_b64 v[68:69], v[20:21]
    v_mov_b64 v[70:71], v[22:23]
    v_mov_b64 v[72:73], v[24:25]
    v_mov_b64 v[74:75], v[26:27]
    v_mov_b64 v[76:77], v[28:29]
    v_mov_b64 v[78:79], v[30:31]
    v_mov_b64 v[80:81], v[32:33]
    v_mov_b64 v[82:83], v[34:35]
    v_mov_b64 v[84:85], v[36:37]
    v_mov_b64 v[86:87], v[38:39]
    v_mov_b64 v[88:89], v[52:53]
    v_mov_b64 v[90:91], v[54:55]
    v_mov_b64 v[92:93], v[56:57]
    v_mov_b64 v[94:95], v[58:59]
su_oe_62:
    s_waitcnt vmcnt(0)
    s_barrier
    ds_read_b64_tr_b16 v[16:17], v48 offset:16384
    ds_read_b64_tr_b16 v[18:19], v48 offset:18432
    ds_read_b64_tr_b16 v[20:21], v49 offset:16384
    ds_read_b64_tr_b16 v[22:23], v49 offset:18432
    ds_read_b64_tr_b16 v[24:25], v48 offset:16392
    ds_read_b64_tr_b16 v[26:27], v48 offset:18440
    ds_read_b64_tr_b16 v[28:29], v49 offset:16392
    ds_read_b64_tr_b16 v[30:31], v49 offset:18440
    s_waitcnt lgkmcnt(4)
    ds_read_b64_tr_b16 v[32:33], v48 offset:16400
    ds_read_b64_tr_b16 v[34:35], v48 offset:18448
    ds_read_b64_tr_b16 v[36:37], v49 offset:16400
    ds_read_b64_tr_b16 v[38:39], v49 offset:18448
    ds_read_b64_tr_b16 v[52:53], v48 offset:16408
    ds_read_b64_tr_b16 v[54:55], v48 offset:18456
    ds_read_b64_tr_b16 v[56:57], v49 offset:16408
    ds_read_b64_tr_b16 v[58:59], v49 offset:18456
    s_waitcnt lgkmcnt(4)
    s_waitcnt lgkmcnt(0)
    s_barrier
    s_cmp_lg_u32 s47, 0
    s_cbranch_scc1 su_ob_63
    ds_write_b128 v5, v[16:19] offset:16384
    ds_write_b128 v5, v[20:23] offset:17408
    ds_write_b128 v5, v[24:27] offset:18432
    ds_write_b128 v5, v[28:31] offset:19456
    ds_write_b128 v5, v[32:35] offset:20480
    ds_write_b128 v5, v[36:39] offset:21504
    ds_write_b128 v5, v[52:55] offset:22528
    ds_write_b128 v5, v[56:59] offset:23552
    s_branch su_oe_64
su_ob_63:
    ds_write_b128 v5, v[96:99] offset:16384
    ds_write_b128 v5, v[100:103] offset:17408
    ds_write_b128 v5, v[104:107] offset:18432
    ds_write_b128 v5, v[108:111] offset:19456
    ds_write_b128 v5, v[112:115] offset:20480
    ds_write_b128 v5, v[116:119] offset:21504
    ds_write_b128 v5, v[120:123] offset:22528
    ds_write_b128 v5, v[124:127] offset:23552
    s_waitcnt lgkmcnt(0)
    v_mov_b64 v[96:97], v[16:17]
    v_mov_b64 v[98:99], v[18:19]
    v_mov_b64 v[100:101], v[20:21]
    v_mov_b64 v[102:103], v[22:23]
    v_mov_b64 v[104:105], v[24:25]
    v_mov_b64 v[106:107], v[26:27]
    v_mov_b64 v[108:109], v[28:29]
    v_mov_b64 v[110:111], v[30:31]
    v_mov_b64 v[112:113], v[32:33]
    v_mov_b64 v[114:115], v[34:35]
    v_mov_b64 v[116:117], v[36:37]
    v_mov_b64 v[118:119], v[38:39]
    v_mov_b64 v[120:121], v[52:53]
    v_mov_b64 v[122:123], v[54:55]
    v_mov_b64 v[124:125], v[56:57]
    v_mov_b64 v[126:127], v[58:59]
su_oe_64:
    s_lshl_b32 s62, s18, 2
    s_cmp_ge_u32 s91, 3
    s_cbranch_scc1 hw_65
    s_cmp_lg_u32 s91, 0
    s_cbranch_scc1 hw1_66
    v_mov_b32 v11, 36
    s_mov_b32 s98, 8000
wp_67:
    global_load_dword v12, v11, s[92:93] sc1
    s_waitcnt vmcnt(0)
    v_cmp_le_u32 vcc, 32, v12
    s_cbranch_vccnz wpok_68
    s_sleep 1
    s_sub_u32 s98, s98, 1
    s_cbranch_scc0 wp_67
    s_branch L_err
wpok_68:
    v_mov_b32 v11, 0
    global_load_dword v12, v11, s[92:93] sc1
    v_mov_b32 v11, 32512
    s_waitcnt vmcnt(0)
    ds_write_b32 v11, v12
    s_branch hw_65
hw1_66:
    v_mov_b32 v11, 44
    s_mov_b32 s98, 8000
wp_69:
    global_load_dword v12, v11, s[92:93] sc1
    s_waitcnt vmcnt(0)
    v_cmp_le_u32 vcc, 48, v12
    s_cbranch_vccnz wpok_70
    s_sleep 1
    s_sub_u32 s98, s98, 1
    s_cbranch_scc0 wp_69
    s_branch L_err
wpok_70:
    s_lshl_b32 s63, s91, 7
    s_add_u32 s63, s63, s62
    s_sub_u32 s63, s63, 128
    v_mov_b32 v11, s63
    s_mov_b32 s98, 8000
wp_71:
    global_load_dword v12, v11, s[96:97] sc1
    s_waitcnt vmcnt(0)
    v_and_b32 v12, 255, v12
    v_cmp_eq_u32 vcc, 4, v12
    s_cbranch_vccnz wpok_72
    s_sleep 1
    s_sub_u32 s98, s98, 1
    s_cbranch_scc0 wp_71
    s_branch L_err
wpok_72:
hw_65:
    s_waitcnt vmcnt(0) lgkmcnt(0)
    s_barrier
    v_mov_b32 v11, 32512
    ds_read_b32 v12, v11
    s_waitcnt lgkmcnt(0)
    v_readfirstlane_b32 s63, v12
    s_mov_b32 s20, 0
    s_cmp_lt_u32 s63, 32
    s_cbranch_scc1 L_slow
    s_cmp_lg_u32 s47, 0
    s_cbranch_scc1 L_roleB_f
    s_setprio 2
A_loop_73:
    s_mov_b64 s[54:55], s[32:33]
    s_mov_b64 s[56:57], s[42:43]
    s_and_b32 s21, s20, 3
    s_lshl_b32 s21, s21, 13
    s_add_u32 s42, s50, s21
    s_addc_u32 s43, s51, 0
    s_lshl_b32 s24, s19, 10
    s_add_u32 s24, s24, 2048
    s_add_u32 s26, s42, s24
    s_addc_u32 s27, s43, 0
    s_add_u32 s61, s20, 1
    s_bfe_u32 s3, s20, 0x10002
    s_and_b32 s21, s61, 3
    s_lshl_b32 s21, s21, 13
    s_add_u32 s28, s50, s21
    s_addc_u32 s29, s51, 0
    s_and_b32 s21, s20, 3
    s_lshl_b32 s21, s21, 18
    s_add_u32 s30, s52, s21
    s_addc_u32 s31, s53, 0
    s_lshl_b32 s21, s18, 13
    s_add_u32 s21, s21, 2048
    s_add_u32 s32, s30, s21
    s_addc_u32 s33, s31, 0
    s_lshl_b32 s21, s19, 10
    v_add_u32 v63, s21, v1
    v_xor_b32 v60, 1024, v63
    v_xor_b32 v61, 2048, v63
    v_xor_b32 v62, 3072, v63
    v_mov_b64 v[48:49], 0
    v_mov_b64 v[50:51], 0
    v_mov_b64 v[52:53], 0
    v_mov_b64 v[54:55], 0
    v_mov_b64 v[56:57], 0
    v_mov_b64 v[58:59], 0
    v_mov_b32 v14, s61
    s_barrier
    global_load_dwordx4 v[16:19], v1, s[26:27] offset:-2048 sc1
    s_nop 7
    s_nop 7
    s_nop 7
    s_mov_b32 s25, 30000
p_loop_75:
    global_load_dwordx4 v[16:19], v1, s[26:27] offset:-2048 sc1
    s_sub_u32 s25, s25, 1
    s_cbranch_scc1 L_err
    s_waitcnt vmcnt(1)
    v_max3_u32 v11, v16, v17, v18
    v_max_u32 v11, v11, v19
    v_cmp_eq_u32 vcc, -1, v11
    s_nop 0
    s_and_b64 exec, exec, vcc
    s_cbranch_execnz p_loop_75
    s_mov_b64 exec, -1
p_ok_74:
    ds_write_b128 v63, v[16:19]
    v_smfmac_f32_16x16x64_bf16 v[48:51], v[16:19], a[0:7], v0
    v_smfmac_f32_16x16x64_bf16 v[52:55], v[16:19], a[64:71], v0
    s_waitcnt lgkmcnt(0)
    s_barrier
    ds_read_b128 v[32:35], v63 offset:4096
    ds_read_b128 v[20:23], v60 offset:0
    ds_read_b128 v[36:39], v60 offset:4096
    ds_read_b128 v[24:27], v61 offset:0
    ds_read_b128 v[40:43], v61 offset:4096
    ds_read_b128 v[28:31], v62 offset:0
    ds_read_b128 v[44:47], v62 offset:4096
    v_smfmac_f32_16x16x64_bf16 v[56:59], v[16:19], v[64:71], v0
    s_waitcnt lgkmcnt(6)
    v_smfmac_f32_16x16x64_bf16 v[48:51], v[32:35], a[32:39], v0
    v_smfmac_f32_16x16x64_bf16 v[52:55], v[32:35], a[96:103], v0
    s_waitcnt lgkmcnt(5)
    v_smfmac_f32_16x16x64_bf16 v[48:51], v[20:23], a[8:15], v0
    v_smfmac_f32_16x16x64_bf16 v[52:55], v[20:23], a[72:79], v0
    s_waitcnt lgkmcnt(4)
    v_smfmac_f32_16x16x64_bf16 v[48:51], v[36:39], a[40:47], v0
    v_smfmac_f32_16x16x64_bf16 v[52:55], v[36:39], a[104:111], v0
    s_waitcnt lgkmcnt(3)
    v_smfmac_f32_16x16x64_bf16 v[48:51], v[24:27], a[16:23], v0
    v_smfmac_f32_16x16x64_bf16 v[52:55], v[24:27], a[80:87], v0
    s_waitcnt lgkmcnt(2)
    v_smfmac_f32_16x16x64_bf16 v[48:51], v[40:43], a[48:55], v0
    v_smfmac_f32_16x16x64_bf16 v[52:55], v[40:43], a[112:119], v0
    s_waitcnt lgkmcnt(1)
    v_smfmac_f32_16x16x64_bf16 v[48:51], v[28:31], a[24:31], v0
    v_smfmac_f32_16x16x64_bf16 v[52:55], v[28:31], a[88:95], v0
    s_waitcnt lgkmcnt(0)
    v_smfmac_f32_16x16x64_bf16 v[48:51], v[44:47], a[56:63], v0
    v_smfmac_f32_16x16x64_bf16 v[52:55], v[44:47], a[120:127], v0
    s_waitcnt vmcnt(0)
    s_add_u32 s34, s34, 262144
    s_addc_u32 s35, s35, 0
    global_load_dword v12, v13, s[34:35]
    ds_read_b128 v[16:19], v1 offset:8192
    s_nop 1
    v_add_f32 v48, v48, v49
    v_add_f32 v50, v50, v51
    v_add_f32 v52, v52, v53
    v_add_f32 v54, v54, v55
    v_cvt_pk_bf16_f32 v48, v48, v52
    v_cvt_pk_bf16_f32 v50, v50, v54
    ds_write2_b32 v2, v48, v50 offset0:0 offset1:72
    ds_write_b32 v7, v14 offset:32528
    s_setprio 0
    v_smfmac_f32_16x16x64_bf16 v[56:59], v[32:35], v[96:103], v0
    ds_read_b128 v[32:35], v1 offset:12288
    v_smfmac_f32_16x16x64_bf16 v[56:59], v[28:31], v[88:95], v0
    v_smfmac_f32_16x16x64_bf16 v[56:59], v[44:47], v[120:127], v0
    v_smfmac_f32_16x16x64_bf16 v[56:59], v[20:23], v[72:79], v0
    v_smfmac_f32_16x16x64_bf16 v[56:59], v[36:39], v[104:111], v0
    ds_read_b128 v[20:23], v1 offset:9216
    ds_read_b128 v[36:39], v1 offset:13312
    s_mov_b32 s25, 30000
fwq_76:
    ds_read_b32 v11, v15 offset:32528
    ds_read_b128 v[48:51], v8 offset:0
    ds_read_b128 v[52:55], v8 offset:64
    ds_read_b128 v[28:31], v8 offset:128
    ds_read_b128 v[44:47], v8 offset:192
    s_sub_u32 s25, s25, 1
    s_cbranch_scc1 L_err
    s_waitcnt lgkmcnt(4)
    v_cmp_gt_u32 vcc, s61, v11
    s_cbranch_vccnz fwq_76
    v_smfmac_f32_16x16x64_bf16 v[56:59], v[24:27], v[80:87], v0
    v_smfmac_f32_16x16x64_bf16 v[56:59], v[40:43], v[112:119], v0
    s_setprio 2
    ds_read_b128 v[24:27], v1 offset:10240
    ds_read_b128 v[40:43], v1 offset:14336
    s_waitcnt lgkmcnt(5)
    v_mfma_f32_16x16x32_bf16 v[60:63], v[16:19], v[48:51], 0
    ds_read_b128 v[16:19], v1 offset:11264
    s_waitcnt lgkmcnt(5)
    v_mfma_f32_16x16x32_bf16 v[60:63], v[20:23], v[52:55], v[60:63]
    s_waitcnt lgkmcnt(2)
    v_mfma_f32_16x16x32_bf16 v[60:63], v[24:27], v[28:31], v[60:63]
    ds_read_b128 v[24:27], v1 offset:15360
    v_mfma_f32_16x16x32_bf16 v[20:23], v[32:35], v[48:51], 0
    v_mfma_f32_16x16x32_bf16 v[20:23], v[36:39], v[52:55], v[20:23]
    s_waitcnt lgkmcnt(1)
    v_mfma_f32_16x16x32_bf16 v[60:63], v[16:19], v[44:47], v[60:63]
    v_mfma_f32_16x16x32_bf16 v[20:23], v[40:43], v[28:31], v[20:23]
    s_mov_b32 s25, 30000
    s_waitcnt lgkmcnt(0)
    v_mfma_f32_16x16x32_bf16 v[20:23], v[24:27], v[44:47], v[20:23]
    ds_read_b32 v11, v15 offset:32544
    ds_read_b128 v[32:35], v9 offset:0
    ds_read_b128 v[36:39], v9 offset:64
    ds_read_b128 v[40:43], v9 offset:128
    ds_read_b128 v[16:19], v9 offset:192
    s_waitcnt lgkmcnt(4)
    v_cmp_gt_u32 vcc, s61, v11
    s_cbranch_vccz fwk_ok_78
fwk_77:
    ds_read_b32 v11, v15 offset:32544
    s_sub_u32 s25, s25, 1
    s_cbranch_scc1 L_err
    s_waitcnt lgkmcnt(0)
    v_cmp_gt_u32 vcc, s61, v11
    s_cbranch_vccnz fwk_77
    ds_read_b128 v[32:35], v9 offset:0
    ds_read_b128 v[36:39], v9 offset:64
    ds_read_b128 v[40:43], v9 offset:128
    ds_read_b128 v[16:19], v9 offset:192
fwk_ok_78:
    v_add_f32 v56, v56, v57
    v_add_f32 v58, v58, v59
    s_waitcnt lgkmcnt(3)
    v_mfma_f32_16x16x32_bf16 v[24:27], v[32:35], v[48:51], 0
    v_cvt_pk_bf16_f32 v56, v56, v58
    v_mov_b32 v57, 0
    s_waitcnt lgkmcnt(2)
    v_mfma_f32_16x16x32_bf16 v[24:27], v[36:39], v[52:55], v[24:27]
    v_max3_f32 v11, v60, v61, v62
    v_max3_f32 v58, v20, v21, v22
    s_waitcnt lgkmcnt(1)
    v_mfma_f32_16x16x32_bf16 v[24:27], v[40:43], v[28:31], v[24:27]
    v_max3_f32 v11, v11, v63, v23
    s_waitcnt lgkmcnt(0)
    v_mfma_f32_16x16x32_bf16 v[24:27], v[16:19], v[44:47], v[24:27]
    global_store_dword v6, v56, s[40:41] sc1
    s_add_u32 s40, s40, 65536
    s_addc_u32 s41, s41, 0
    s_cmp_eq_u32 s20, 63
    s_cbranch_scc1 L_rec_done
    s_lshl_b32 s21, s19, 11
    v_add_u32 v59, s21, v1
    ds_read_b128 v[32:35], v59 offset:16384
    ds_read_b128 v[36:39], v59 offset:17408
    v_lshrrev_b32 v17, 2, v1
    s_lshl_b32 s21, s19, 8
    v_add_u32 v17, s21, v17
    v_max3_f32 v11, v11, v58, v24
    v_max_f32 v11, v11, v25
    v_mov_b32 v58, v11
    s_nop 1
    v_permlane32_swap_b32 v11, v58
    v_max_f32 v11, v11, v58
    v_mov_b32 v58, v11
    s_nop 1
    v_permlane16_swap_b32 v11, v58
    v_max_f32 v11, v11, v58
    v_mul_f32 v11, s46, v11
    v_fma_f32 v60, v60, s46, -v11
    v_exp_f32 v60, v60
    v_fma_f32 v61, v61, s46, -v11
    v_exp_f32 v61, v61
    v_fma_f32 v62, v62, s46, -v11
    v_exp_f32 v62, v62
    v_fma_f32 v63, v63, s46, -v11
    v_exp_f32 v63, v63
    v_fma_f32 v20, v20, s46, -v11
    v_exp_f32 v20, v20
    v_fma_f32 v21, v21, s46, -v11
    v_exp_f32 v21, v21
    v_fma_f32 v22, v22, s46, -v11
    v_exp_f32 v22, v22
    v_fma_f32 v23, v23, s46, -v11
    v_exp_f32 v23, v23
    v_cvt_pk_bf16_f32 v60, v60, v61
    v_cvt_pk_bf16_f32 v61, v62, v63
    v_cvt_pk_bf16_f32 v62, v20, v21
    v_cvt_pk_bf16_f32 v63, v22, v23
    v_mov_b32 v44, 0x3f803f80
    v_mov_b32 v45, 0x3f803f80
    v_mov_b64 v[46:47], v[44:45]
    s_mov_b32 s25, 30000
    ds_read_b32 v16, v7 offset:32560
    ds_read_b32 v40, v17 offset:31488
    s_waitcnt lgkmcnt(2)
    v_mfma_f32_16x16x32_bf16 v[28:31], v[44:47], v[60:63], 0
    v_fma_f32 v58, v24, s46, -v11
    v_fma_f32 v59, v25, s46, -v11
    v_mfma_f32_16x16x32_bf16 v[48:51], v[32:35], v[60:63], 0
    v_exp_f32 v58, v58
    v_exp_f32 v59, v59
    v_mfma_f32_16x16x32_bf16 v[52:55], v[36:39], v[60:63], 0
    v_mov_b32 v27, 0
    v_cvt_pk_bf16_f32 v26, v58, v59
    v_mov_b32 v41, 0
    s_branch fwv_in_80
fwv_79:
    ds_read_b32 v16, v7 offset:32560
    ds_read_b32 v40, v17 offset:31488
    s_sub_u32 s25, s25, 1
    s_cbranch_scc1 L_err
fwv_in_80:
    s_waitcnt lgkmcnt(0)
    v_cmp_gt_u32 vcc, s61, v16
    s_cbranch_vccnz fwv_79
    v_mfma_f32_16x16x16_bf16 v[28:31], v[44:45], v[26:27], v[28:31]
    v_mfma_f32_16x16x16_bf16 v[48:51], v[56:57], v[26:27], v[48:51]
    v_mfma_f32_16x16x16_bf16 v[52:55], v[40:41], v[26:27], v[52:55]
    ds_read_b128 v[16:19], v5 offset:0
    ds_read_b128 v[20:23], v5 offset:1024
    ds_read_b128 v[32:35], v5 offset:2048
    ds_read_b128 v[36:39], v5 offset:3072
    s_nop 1
    v_rcp_f32 v58, v28
    s_nop 0
    v_mul_f32 v48, v48, v58
    v_mul_f32 v49, v49, v58
    v_cvt_pk_bf16_f32 v60, v48, v49
    v_mul_f32 v50, v50, v58
    v_mul_f32 v51, v51, v58
    v_cvt_pk_bf16_f32 v61, v50, v51
    v_mul_f32 v52, v52, v58
    v_mul_f32 v53, v53, v58
    v_cvt_pk_bf16_f32 v62, v52, v53
    v_mul_f32 v54, v54, v58
    v_mul_f32 v55, v55, v58
    v_cvt_pk_bf16_f32 v63, v54, v55
    ds_write_b128 v10, v[60:63]
    ds_read_b128 v[40:43], v5 offset:4096
    ds_read_b128 v[44:47], v5 offset:5120
    v_mov_b64 v[48:49], 0
    v_mov_b64 v[50:51], 0
    v_mov_b64 v[52:53], 0
    v_mov_b64 v[54:55], 0
    v_mov_b64 v[56:57], 0
    v_mov_b64 v[58:59], 0
    s_waitcnt lgkmcnt(2)
    s_barrier
    v_mov_b64 v[60:61], 0
    v_mov_b64 v[62:63], 0
    ds_read_b128 v[24:27], v3
    ds_read_b128 v[28:31], v3 offset:128
    s_waitcnt lgkmcnt(1)
    v_smfmac_f32_16x16x64_bf16 v[48:51], v[24:27], v[16:23], v0
    ds_read_b128 v[16:19], v5 offset:6144
    ds_read_b128 v[20:23], v5 offset:7168
    v_smfmac_f32_16x16x64_bf16 v[52:55], v[24:27], v[32:39], v0
    ds_read_b128 v[32:35], v5 offset:16384
    ds_read_b128 v[36:39], v5 offset:17408
    v_smfmac_f32_16x16x64_bf16 v[56:59], v[24:27], v[40:47], v0
    ds_read_b128 v[40:43], v5 offset:18432
    ds_read_b128 v[44:47], v5 offset:19456
    s_waitcnt lgkmcnt(4)
    v_smfmac_f32_16x16x64_bf16 v[60:63], v[24:27], v[16:23], v0
    ds_read_b128 v[16:19], v5 offset:20480
    ds_read_b128 v[20:23], v5 offset:21504
    s_waitcnt lgkmcnt(4)
    v_smfmac_f32_16x16x64_bf16 v[48:51], v[28:31], v[32:39], v0
    ds_read_b128 v[32:35], v5 offset:22528
    ds_read_b128 v[36:39], v5 offset:23552
    s_waitcnt lgkmcnt(4)
    v_smfmac_f32_16x16x64_bf16 v[52:55], v[28:31], v[40:47], v0
    s_waitcnt lgkmcnt(2)
    v_smfmac_f32_16x16x64_bf16 v[56:59], v[28:31], v[16:23], v0
    s_waitcnt lgkmcnt(0)
    v_smfmac_f32_16x16x64_bf16 v[60:63], v[28:31], v[32:39], v0
    v_add_f32 v48, v48, v49
    v_add_f32 v50, v50, v51
    s_nop 1
    v_add_f32 v52, v52, v53
    v_add_f32 v54, v54, v55
    v_add_f32 v56, v56, v57
    v_add_f32 v58, v58, v59
    v_add_f32 v60, v60, v61
    v_add_f32 v62, v62, v63
    v_cvt_pk_bf16_f32 v48, v48, v52
    v_cvt_pk_bf16_f32 v49, v56, v60
    v_cvt_pk_bf16_f32 v50, v50, v54
    v_cvt_pk_bf16_f32 v51, v58, v62
    v_bfi_b32 v48, 1, s3, v48
    v_bfi_b32 v49, 1, s3, v49
    v_bfi_b32 v50, 1, s3, v50
    v_bfi_b32 v51, 1, s3, v51
    global_store_dwordx4 v4, v[48:51], s[30:31]
    s_add_u32 s20, s20, 1
    s_nop 3
    s_branch A_loop_73
L_roleB_f:
    s_lshl_b32 s21, s19, 11
    s_add_u32 m0, s21, 8192
    s_nop 0
    global_load_lds_dwordx4 v1, s[34:35]
    global_load_lds_dwordx4 v1, s[34:35] offset:1024
    s_add_u32 m0, s21, 16384
    s_nop 0
    global_load_lds_dwordx4 v1, s[36:37]
    global_load_lds_dwordx4 v1, s[36:37] offset:1024
    s_add_u32 s34, s34, 262144
    s_addc_u32 s35, s35, 0
    s_add_u32 s36, s36, 262144
    s_addc_u32 s37, s37, 0
    v_mov_b32 v14, 0
    s_setprio 0
    s_mov_b64 s[54:55], s[32:33]
    s_mov_b64 s[56:57], s[42:43]
    s_and_b32 s21, s20, 3
    s_lshl_b32 s21, s21, 13
    s_add_u32 s42, s50, s21
    s_addc_u32 s43, s51, 0
    s_lshl_b32 s24, s19, 10
    s_add_u32 s24, s24, 2048
    s_add_u32 s26, s42, s24
    s_addc_u32 s27, s43, 0
    s_add_u32 s61, s20, 1
    s_bfe_u32 s3, s20, 0x10002
    s_and_b32 s21, s61, 3
    s_lshl_b32 s21, s21, 13
    s_add_u32 s28, s50, s21
    s_addc_u32 s29, s51, 0
    s_and_b32 s21, s20, 3
    s_lshl_b32 s21, s21, 18
    s_add_u32 s30, s52, s21
    s_addc_u32 s31, s53, 0
    s_lshl_b32 s21, s18, 13
    s_add_u32 s21, s21, 2048
    s_add_u32 s32, s30, s21
    s_addc_u32 s33, s31, 0
B_loop_81:
    s_barrier
    global_load_dwordx4 v[56:59], v1, s[26:27] offset:2048 sc1
    ds_read_b128 v[36:39], v5 offset:16384
    ds_read_b128 v[40:43], v5 offset:17408
    v_xor_b32 v60, 1024, v8
    v_xor_b32 v61, 2048, v8
    v_xor_b32 v62, 3072, v8
    v_mov_b64 v[16:17], 0
    v_mov_b64 v[18:19], 0
    v_mov_b64 v[20:21], 0
    v_mov_b64 v[22:23], 0
    v_mov_b64 v[24:25], 0
    v_mov_b64 v[26:27], 0
    v_mov_b32 v13, s61
    s_mov_b32 s25, 30000
p_loop_83:
    global_load_dwordx4 v[56:59], v1, s[26:27] offset:2048 sc1
    s_sub_u32 s25, s25, 1
    s_cbranch_scc1 L_err
    s_waitcnt vmcnt(1)
    v_max3_u32 v11, v56, v57, v58
    v_max_u32 v11, v11, v59
    v_cmp_eq_u32 vcc, -1, v11
    s_nop 0
    s_and_b64 exec, exec, vcc
    s_cbranch_execnz p_loop_83
    s_mov_b64 exec, -1
p_ok_82:
    s_setprio 1
    ds_write_b128 v8, v[56:59] offset:4096
    v_smfmac_f32_16x16x64_bf16 v[16:19], v[56:59], a[32:39], v0
    v_smfmac_f32_16x16x64_bf16 v[20:23], v[56:59], a[96:103], v0
    s_waitcnt lgkmcnt(0)
    s_barrier
    v_smfmac_f32_16x16x64_bf16 v[24:27], v[56:59], v[36:43], v0
    ds_read_b128 v[28:31], v8
    ds_read_b128 v[32:35], v60 offset:0
    ds_read_b128 v[36:39], v60 offset:4096
    ds_read_b128 v[40:43], v61 offset:0
    ds_read_b128 v[44:47], v61 offset:4096
    ds_read_b128 v[48:51], v62 offset:0
    ds_read_b128 v[52:55], v62 offset:4096
    s_waitcnt lgkmcnt(6)
    v_smfmac_f32_16x16x64_bf16 v[16:19], v[28:31], a[0:7], v0
    v_smfmac_f32_16x16x64_bf16 v[20:23], v[28:31], a[64:71], v0
    s_waitcnt lgkmcnt(5)
    v_smfmac_f32_16x16x64_bf16 v[16:19], v[32:35], a[8:15], v0
    v_smfmac_f32_16x16x64_bf16 v[20:23], v[32:35], a[72:79], v0
    s_waitcnt lgkmcnt(4)
    v_smfmac_f32_16x16x64_bf16 v[16:19], v[36:39], a[40:47], v0
    v_smfmac_f32_16x16x64_bf16 v[20:23], v[36:39], a[104:111], v0
    s_waitcnt vmcnt(0)
    ds_read_b128 v[56:59], v5 offset:0
    ds_read_b128 v[60:63], v5 offset:1024
    s_waitcnt lgkmcnt(5)
    v_smfmac_f32_16x16x64_bf16 v[16:19], v[40:43], a[16:23], v0
    v_smfmac_f32_16x16x64_bf16 v[20:23], v[40:43], a[80:87], v0
    s_waitcnt lgkmcnt(4)
    v_smfmac_f32_16x16x64_bf16 v[16:19], v[44:47], a[48:55], v0
    v_smfmac_f32_16x16x64_bf16 v[20:23], v[44:47], a[112:119], v0
    s_waitcnt lgkmcnt(3)
    v_smfmac_f32_16x16x64_bf16 v[16:19], v[48:51], a[24:31], v0
    v_smfmac_f32_16x16x64_bf16 v[20:23], v[48:51], a[88:95], v0
    s_waitcnt lgkmcnt(2)
    v_smfmac_f32_16x16x64_bf16 v[16:19], v[52:55], a[56:63], v0
    v_smfmac_f32_16x16x64_bf16 v[20:23], v[52:55], a[120:127], v0
    s_nop 6
    v_add_f32 v16, v16, v17
    v_add_f32 v18, v18, v19
    v_add_f32 v20, v20, v21
    v_add_f32 v22, v22, v23
    v_cvt_pk_bf16_f32 v11, v16, v20
    v_cvt_pk_bf16_f32 v12, v18, v22
    ds_write2_b32 v2, v11, v12 offset0:0 offset1:72
    ds_write_b32 v7, v13 offset:32544
    s_setprio 0
    ds_read_b128 v[16:19], v5 offset:2048
    ds_read_b128 v[20:23], v5 offset:3072
    s_waitcnt lgkmcnt(4)
    v_smfmac_f32_16x16x64_bf16 v[24:27], v[28:31], v[56:63], v0
    ds_read_b128 v[56:59], v5 offset:18432
    ds_read_b128 v[60:63], v5 offset:19456
    s_waitcnt lgkmcnt(2)
    v_smfmac_f32_16x16x64_bf16 v[24:27], v[32:35], v[16:23], v0
    ds_read_b128 v[16:19], v5 offset:4096
    ds_read_b128 v[20:23], v5 offset:5120
    ds_read_b128 v[28:31], v5 offset:20480
    ds_read_b128 v[32:35], v5 offset:21504
    s_waitcnt lgkmcnt(4)
    v_smfmac_f32_16x16x64_bf16 v[24:27], v[36:39], v[56:63], v0
    ds_read_b128 v[56:59], v5 offset:6144
    ds_read_b128 v[60:63], v5 offset:7168
    s_waitcnt lgkmcnt(4)
    v_smfmac_f32_16x16x64_bf16 v[24:27], v[40:43], v[16:23], v0
    ds_read_b128 v[16:19], v5 offset:22528
    ds_read_b128 v[20:23], v5 offset:23552
    s_waitcnt lgkmcnt(4)
    v_smfmac_f32_16x16x64_bf16 v[24:27], v[44:47], v[28:35], v0
    s_waitcnt lgkmcnt(2)
    v_smfmac_f32_16x16x64_bf16 v[24:27], v[48:51], v[56:63], v0
    v_lshrrev_b32 v12, 2, v8
    s_waitcnt lgkmcnt(0)
    v_smfmac_f32_16x16x64_bf16 v[24:27], v[52:55], v[16:23], v0
    s_nop 7
    v_add_f32 v24, v24, v25
    v_add_f32 v26, v26, v27
    v_cvt_pk_bf16_f32 v11, v24, v26
    ds_write_b32 v12, v11 offset:31488
    ds_write_b32 v7, v13 offset:32560
    s_cmp_lg_u32 s19, 0
    s_cbranch_scc1 nprog_84
    s_lshl_b32 s21, s18, 7
    s_add_u32 s21, s21, 8192
    v_mov_b32 v32, s21
    v_mov_b32 v33, s20
    s_mov_b64 exec, 1
    global_store_dword v32, v33, s[96:97] sc1
    s_mov_b64 exec, -1
nprog_84:
    v_lshrrev_b32 v12, 6, v1
    v_and_b32 v12, 7, v12
    v_mul_u32_u24 v12, 288, v12
    v_and_b32 v32, 0x30, v1
    v_add_u32 v12, v12, v32
    v_lshl_add_u32 v12, v7, 4, v12
    ds_read_b128 v[36:39], v12 offset:26880
    v_mov_b32 v32, v11
    v_mov_b32 v33, v11
    v_mov_b32 v34, v11
    v_mov_b32 v35, v11
    s_nop 0
    v_permlane32_swap_b32 v32, v34
    v_permlane32_swap_b32 v33, v35
    s_nop 1
    v_permlane16_swap_b32 v32, v33
    v_permlane16_swap_b32 v34, v35
    s_mov_b64 exec, 0xffff
    global_store_dwordx4 v6, v[32:35], s[40:41] sc1
    s_mov_b64 exec, -1
    s_add_u32 s40, s40, 65536
    s_addc_u32 s41, s41, 0
    s_waitcnt lgkmcnt(0)
    s_mov_b64 exec, 0xffffffff
    global_store_dwordx4 v10, v[36:39], s[38:39] sc1
    s_mov_b64 exec, -1
    s_add_u32 s38, s38, 65536
    s_addc_u32 s39, s39, 0
    s_cmp_eq_u32 s20, 63
    s_cbranch_scc1 L_rec_done
    s_add_u32 s62, s62, 128
    v_mov_b32 v15, s62
    s_cmp_ge_u32 s20, 62
    s_cbranch_scc1 cntok_85
    s_mov_b32 s25, 8000
cntsp_86:
    v_and_b32 v14, 0xff, v14
    v_cmp_eq_u32 vcc, 4, v14
    s_cbranch_vccnz cntok_85
    global_load_dword v14, v15, s[96:97] offset:128 sc1
    s_sub_u32 s25, s25, 1
    s_cbranch_scc1 L_err
    s_waitcnt vmcnt(0)
    s_branch cntsp_86
cntok_85:
    global_load_dword v14, v15, s[96:97] offset:256 sc1
    s_cmp_eq_u32 s20, 0
    s_cbranch_scc1 norearm_87
    v_mov_b64 v[32:33], -1
    s_mov_b64 exec, s[58:59]
    global_store_dwordx2 v9, v[32:33], s[56:57]
    s_mov_b64 exec, -1
norearm_87:
    v_mov_b64 v[48:49], 0
    v_mov_b64 v[50:51], 0
    v_mov_b64 v[52:53], 0
    v_mov_b64 v[54:55], 0
    v_mov_b64 v[56:57], 0
    v_mov_b64 v[58:59], 0
    v_mov_b64 v[60:61], 0
    v_mov_b64 v[62:63], 0
    s_waitcnt lgkmcnt(0)
    s_barrier
    ds_read_b128 v[16:19], v3
    ds_read_b128 v[20:23], v3 offset:128
    s_lshl_b32 s21, s19, 11
    s_add_u32 m0, s21, 8192
    s_nop 0
    global_load_lds_dwordx4 v1, s[34:35]
    global_load_lds_dwordx4 v1, s[34:35] offset:1024
    s_add_u32 m0, s21, 16384
    s_nop 0
    global_load_lds_dwordx4 v1, s[36:37]
    global_load_lds_dwordx4 v1, s[36:37] offset:1024
    s_add_u32 s34, s34, 262144
    s_addc_u32 s35, s35, 0
    s_add_u32 s36, s36, 262144
    s_addc_u32 s37, s37, 0
    s_setprio 3
    s_waitcnt lgkmcnt(1)
    v_smfmac_f32_16x16x64_bf16 v[48:51], v[16:19], v[64:71], v0
    v_smfmac_f32_16x16x64_bf16 v[52:55], v[16:19], v[72:79], v0
    v_smfmac_f32_16x16x64_bf16 v[56:59], v[16:19], v[80:87], v0
    v_smfmac_f32_16x16x64_bf16 v[60:63], v[16:19], v[88:95], v0
    s_waitcnt lgkmcnt(0)
    v_smfmac_f32_16x16x64_bf16 v[48:51], v[20:23], v[96:103], v0
    v_smfmac_f32_16x16x64_bf16 v[52:55], v[20:23], v[104:111], v0
    v_smfmac_f32_16x16x64_bf16 v[56:59], v[20:23], v[112:119], v0
    v_smfmac_f32_16x16x64_bf16 v[60:63], v[20:23], v[120:127], v0
    s_nop 4
    v_add_f32 v48, v48, v49
    v_add_f32 v50, v50, v51
    v_add_f32 v52, v52, v53
    v_add_f32 v54, v54, v55
    v_add_f32 v56, v56, v57
    v_add_f32 v58, v58, v59
    v_add_f32 v60, v60, v61
    v_add_f32 v62, v62, v63
    v_cvt_pk_bf16_f32 v48, v48, v52
    v_cvt_pk_bf16_f32 v49, v56, v60
    v_cvt_pk_bf16_f32 v50, v50, v54
    v_cvt_pk_bf16_f32 v51, v58, v62
    v_bfi_b32 v48, 1, s3, v48
    v_bfi_b32 v49, 1, s3, v49
    v_bfi_b32 v50, 1, s3, v50
    v_bfi_b32 v51, 1, s3, v51
    global_store_dwordx4 v4, v[48:51], s[30:31]
    s_setprio 0
    v_bfe_u32 v41, v1, 4, 2
    v_bfe_u32 v42, v1, 6, 2
    v_cmp_eq_u32 vcc, 3, v41
    v_mov_b32 v43, 0x3f80
    v_mov_b32 v44, 0x3f800000
    v_cndmask_b32 v43, v43, v44, vcc
    v_cndmask_b32 v41, v41, 0, vcc
    v_or_b32 v41, 12, v41
    v_mul_u32_u24 v40, 0x1111, v41
    v_cmp_eq_u32 vcc, 0, v42
    s_nop 1
    v_cndmask_b32 v36, 0, v43, vcc
    v_cmp_eq_u32 vcc, 1, v42
    s_nop 1
    v_cndmask_b32 v37, 0, v43, vcc
    v_mov_b64 v[38:39], v[36:37]
    v_mov_b64 v[44:45], 0
    v_mov_b64 v[46:47], 0
    s_mov_b64 s[48:49], s[28:29]
    s_mov_b32 s22, s3
    s_add_u32 s20, s20, 1
    s_mov_b64 s[54:55], s[32:33]
    s_mov_b64 s[56:57], s[42:43]
    s_and_b32 s21, s20, 3
    s_lshl_b32 s21, s21, 13
    s_add_u32 s42, s50, s21
    s_addc_u32 s43, s51, 0
    s_lshl_b32 s24, s19, 10
    s_add_u32 s24, s24, 2048
    s_add_u32 s26, s42, s24
    s_addc_u32 s27, s43, 0
    s_add_u32 s61, s20, 1
    s_bfe_u32 s3, s20, 0x10002
    s_and_b32 s21, s61, 3
    s_lshl_b32 s21, s21, 13
    s_add_u32 s28, s50, s21
    s_addc_u32 s29, s51, 0
    s_and_b32 s21, s20, 3
    s_lshl_b32 s21, s21, 18
    s_add_u32 s30, s52, s21
    s_addc_u32 s31, s53, 0
    s_lshl_b32 s21, s18, 13
    s_add_u32 s21, s21, 2048
    s_add_u32 s32, s30, s21
    s_addc_u32 s33, s31, 0
    s_nop 15
    s_nop 15
    s_nop 15
    s_cmp_lg_u32 s22, 0
    s_cbranch_scc1 tag1_88
    s_mov_b32 s25, 30000
    global_load_dwordx4 v[28:31], v8, s[54:55] offset:-2048 sc1
    global_load_dwordx4 v[32:35], v8, s[54:55] offset:2048 sc1
    s_waitcnt vmcnt(0)
    v_bitop3_b32 v11, v28, v29, v30 bitop3:0xfe
    v_bitop3_b32 v12, v32, v33, v34 bitop3:0xfe
    v_bitop3_b32 v11, v11, v31, v35 bitop3:0xfe
    v_bitop3_b32 v11, v11, v12, 1 bitop3:0xa8
    v_cmp_ne_u32 vcc, 0, v11
    s_cbranch_vccz p_ok_90
    s_mov_b64 exec, vcc
    global_load_dwordx4 v[28:31], v8, s[54:55] offset:-2048 sc1
    global_load_dwordx4 v[32:35], v8, s[54:55] offset:2048 sc1
    s_nop 7
    s_nop 7
p_loop_91:
    global_load_dwordx4 v[28:31], v8, s[54:55] offset:-2048 sc1
    global_load_dwordx4 v[32:35], v8, s[54:55] offset:2048 sc1
    s_sub_u32 s25, s25, 1
    s_cbranch_scc1 L_err
    s_waitcnt vmcnt(2)
    v_bitop3_b32 v11, v28, v29, v30 bitop3:0xfe
    v_bitop3_b32 v12, v32, v33, v34 bitop3:0xfe
    v_bitop3_b32 v11, v11, v31, v35 bitop3:0xfe
    v_bitop3_b32 v11, v11, v12, 1 bitop3:0xa8
    v_cmp_ne_u32 vcc, 0, v11
    s_nop 0
    s_and_b64 exec, exec, vcc
    s_cbranch_execnz p_loop_91
    s_mov_b64 exec, -1
p_ok_90:
    s_branch tagd_89
tag1_88:
    s_mov_b32 s25, 30000
    global_load_dwordx4 v[28:31], v8, s[54:55] offset:-2048 sc1
    global_load_dwordx4 v[32:35], v8, s[54:55] offset:2048 sc1
    s_waitcnt vmcnt(0)
    v_bitop3_b32 v11, v28, v29, v30 bitop3:0x80
    v_bitop3_b32 v12, v32, v33, v34 bitop3:0x80
    v_bitop3_b32 v11, v11, v31, v35 bitop3:0x80
    v_bitop3_b32 v11, v11, v12, 1 bitop3:0x80
    v_cmp_ne_u32 vcc, 1, v11
    s_cbranch_vccz p_ok_92
    s_mov_b64 exec, vcc
    global_load_dwordx4 v[28:31], v8, s[54:55] offset:-2048 sc1
    global_load_dwordx4 v[32:35], v8, s[54:55] offset:2048 sc1
    s_nop 7
    s_nop 7
p_loop_93:
    global_load_dwordx4 v[28:31], v8, s[54:55] offset:-2048 sc1
    global_load_dwordx4 v[32:35], v8, s[54:55] offset:2048 sc1
    s_sub_u32 s25, s25, 1
    s_cbranch_scc1 L_err
    s_waitcnt vmcnt(2)
    v_bitop3_b32 v11, v28, v29, v30 bitop3:0x80
    v_bitop3_b32 v12, v32, v33, v34 bitop3:0x80
    v_bitop3_b32 v11, v11, v31, v35 bitop3:0x80
    v_bitop3_b32 v11, v11, v12, 1 bitop3:0x80
    v_cmp_ne_u32 vcc, 1, v11
    s_nop 0
    s_and_b64 exec, exec, vcc
    s_cbranch_execnz p_loop_93
    s_mov_b64 exec, -1
p_ok_92:
tagd_89:
    v_smfmac_f32_16x16x64_bf16 v[44:47], v[36:39], v[28:35], v40
    s_nop 7
    v_add_f32_dpp v44, v44, v44 row_ror:4 row_mask:0xf bank_mask:0xf
    v_add_f32_dpp v45, v45, v45 row_ror:4 row_mask:0xf bank_mask:0xf
    v_add_f32_dpp v46, v46, v46 row_ror:4 row_mask:0xf bank_mask:0xf
    v_add_f32_dpp v47, v47, v47 row_ror:4 row_mask:0xf bank_mask:0xf
    v_add_f32_dpp v44, v44, v44 row_ror:8 row_mask:0xf bank_mask:0xf
    v_add_f32_dpp v45, v45, v45 row_ror:8 row_mask:0xf bank_mask:0xf
    v_add_f32_dpp v46, v46, v46 row_ror:8 row_mask:0xf bank_mask:0xf
    v_add_f32_dpp v47, v47, v47 row_ror:8 row_mask:0xf bank_mask:0xf
    v_cvt_pk_bf16_f32 v44, v44, v45
    v_cvt_pk_bf16_f32 v45, v46, v47
    s_mov_b64 exec, s[58:59]
    global_store_dwordx2 v9, v[44:45], s[48:49]
    s_mov_b64 exec, -1
    s_branch B_loop_81
L_slow:
    s_cmp_lg_u32 s47, 0
    s_cbranch_scc1 L_roleB_s
    s_setprio 2
A_loop_94:
    s_mov_b64 s[54:55], s[32:33]
    s_mov_b64 s[56:57], s[42:43]
    s_and_b32 s21, s20, 3
    s_lshl_b32 s21, s21, 13
    s_add_u32 s42, s50, s21
    s_addc_u32 s43, s51, 0
    s_lshl_b32 s24, s19, 10
    s_add_u32 s24, s24, 2048
    s_add_u32 s26, s42, s24
    s_addc_u32 s27, s43, 0
    s_add_u32 s61, s20, 1
    s_bfe_u32 s3, s20, 0x10002
    s_and_b32 s21, s61, 3
    s_lshl_b32 s21, s21, 13
    s_add_u32 s28, s50, s21
    s_addc_u32 s29, s51, 0
    s_and_b32 s21, s20, 3
    s_lshl_b32 s21, s21, 18
    s_add_u32 s30, s52, s21
    s_addc_u32 s31, s53, 0
    s_lshl_b32 s21, s18, 13
    s_add_u32 s21, s21, 2048
    s_add_u32 s32, s30, s21
    s_addc_u32 s33, s31, 0
    s_lshl_b32 s21, s19, 10
    v_add_u32 v63, s21, v1
    v_xor_b32 v60, 1024, v63
    v_xor_b32 v61, 2048, v63
    v_xor_b32 v62, 3072, v63
    v_mov_b64 v[48:49], 0
    v_mov_b64 v[50:51], 0
    v_mov_b64 v[52:53], 0
    v_mov_b64 v[54:55], 0
    v_mov_b64 v[56:57], 0
    v_mov_b64 v[58:59], 0
    v_mov_b32 v14, s61
    s_barrier
    global_load_dwordx4 v[16:19], v1, s[26:27] offset:-2048 sc1
    s_nop 7
    s_nop 7
    s_nop 7
    s_mov_b32 s25, 30000
p_loop_96:
    global_load_dwordx4 v[16:19], v1, s[26:27] offset:-2048 sc1
    s_sub_u32 s25, s25, 1
    s_cbranch_scc1 L_err
    s_waitcnt vmcnt(1)
    v_max3_u32 v11, v16, v17, v18
    v_max_u32 v11, v11, v19
    v_cmp_eq_u32 vcc, -1, v11
    s_nop 0
    s_and_b64 exec, exec, vcc
    s_cbranch_execnz p_loop_96
    s_mov_b64 exec, -1
p_ok_95:
    ds_write_b128 v63, v[16:19]
    v_smfmac_f32_16x16x64_bf16 v[48:51], v[16:19], a[0:7], v0
    v_smfmac_f32_16x16x64_bf16 v[52:55], v[16:19], a[64:71], v0
    s_waitcnt lgkmcnt(0)
    s_barrier
    ds_read_b128 v[32:35], v63 offset:4096
    ds_read_b128 v[20:23], v60 offset:0
    ds_read_b128 v[36:39], v60 offset:4096
    ds_read_b128 v[24:27], v61 offset:0
    ds_read_b128 v[40:43], v61 offset:4096
    ds_read_b128 v[28:31], v62 offset:0
    ds_read_b128 v[44:47], v62 offset:4096
    v_smfmac_f32_16x16x64_bf16 v[56:59], v[16:19], v[64:71], v0
    s_waitcnt lgkmcnt(6)
    v_smfmac_f32_16x16x64_bf16 v[48:51], v[32:35], a[32:39], v0
    v_smfmac_f32_16x16x64_bf16 v[52:55], v[32:35], a[96:103], v0
    s_waitcnt lgkmcnt(5)
    v_smfmac_f32_16x16x64_bf16 v[48:51], v[20:23], a[8:15], v0
    v_smfmac_f32_16x16x64_bf16 v[52:55], v[20:23], a[72:79], v0
    s_waitcnt lgkmcnt(4)
    v_smfmac_f32_16x16x64_bf16 v[48:51], v[36:39], a[40:47], v0
    v_smfmac_f32_16x16x64_bf16 v[52:55], v[36:39], a[104:111], v0
    s_waitcnt lgkmcnt(3)
    v_smfmac_f32_16x16x64_bf16 v[48:51], v[24:27], a[16:23], v0
    v_smfmac_f32_16x16x64_bf16 v[52:55], v[24:27], a[80:87], v0
    s_waitcnt lgkmcnt(2)
    v_smfmac_f32_16x16x64_bf16 v[48:51], v[40:43], a[48:55], v0
    v_smfmac_f32_16x16x64_bf16 v[52:55], v[40:43], a[112:119], v0
    s_waitcnt lgkmcnt(1)
    v_smfmac_f32_16x16x64_bf16 v[48:51], v[28:31], a[24:31], v0
    v_smfmac_f32_16x16x64_bf16 v[52:55], v[28:31], a[88:95], v0
    s_waitcnt lgkmcnt(0)
    v_smfmac_f32_16x16x64_bf16 v[48:51], v[44:47], a[56:63], v0
    v_smfmac_f32_16x16x64_bf16 v[52:55], v[44:47], a[120:127], v0
    s_waitcnt vmcnt(0)
    s_add_u32 s34, s34, 262144
    s_addc_u32 s35, s35, 0
    global_load_dword v12, v13, s[34:35]
    ds_read_b128 v[16:19], v1 offset:8192
    s_nop 1
    v_add_f32 v48, v48, v49
    v_add_f32 v50, v50, v51
    v_add_f32 v52, v52, v53
    v_add_f32 v54, v54, v55
    v_cvt_pk_bf16_f32 v48, v48, v52
    v_cvt_pk_bf16_f32 v50, v50, v54
    ds_write2_b32 v2, v48, v50 offset0:0 offset1:72
    ds_write_b32 v7, v14 offset:32528
    s_setprio 0
    v_smfmac_f32_16x16x64_bf16 v[56:59], v[32:35], v[96:103], v0
    ds_read_b128 v[32:35], v1 offset:12288
    v_smfmac_f32_16x16x64_bf16 v[56:59], v[28:31], v[88:95], v0
    v_smfmac_f32_16x16x64_bf16 v[56:59], v[44:47], v[120:127], v0
    v_smfmac_f32_16x16x64_bf16 v[56:59], v[20:23], v[72:79], v0
    v_smfmac_f32_16x16x64_bf16 v[56:59], v[36:39], v[104:111], v0
    ds_read_b128 v[20:23], v1 offset:9216
    ds_read_b128 v[36:39], v1 offset:13312
    s_mov_b32 s25, 30000
fwq_97:
    ds_read_b32 v11, v15 offset:32528
    ds_read_b128 v[48:51], v8 offset:0
    ds_read_b128 v[52:55], v8 offset:64
    ds_read_b128 v[28:31], v8 offset:128
    ds_read_b128 v[44:47], v8 offset:192
    s_sub_u32 s25, s25, 1
    s_cbranch_scc1 L_err
    s_waitcnt lgkmcnt(4)
    v_cmp_gt_u32 vcc, s61, v11
    s_cbranch_vccnz fwq_97
    v_smfmac_f32_16x16x64_bf16 v[56:59], v[24:27], v[80:87], v0
    v_smfmac_f32_16x16x64_bf16 v[56:59], v[40:43], v[112:119], v0
    s_setprio 2
    ds_read_b128 v[24:27], v1 offset:10240
    ds_read_b128 v[40:43], v1 offset:14336
    s_waitcnt lgkmcnt(5)
    v_mfma_f32_16x16x32_bf16 v[60:63], v[16:19], v[48:51], 0
    ds_read_b128 v[16:19], v1 offset:11264
    s_waitcnt lgkmcnt(5)
    v_mfma_f32_16x16x32_bf16 v[60:63], v[20:23], v[52:55], v[60:63]
    s_waitcnt lgkmcnt(2)
    v_mfma_f32_16x16x32_bf16 v[60:63], v[24:27], v[28:31], v[60:63]
    ds_read_b128 v[24:27], v1 offset:15360
    v_mfma_f32_16x16x32_bf16 v[20:23], v[32:35], v[48:51], 0
    v_mfma_f32_16x16x32_bf16 v[20:23], v[36:39], v[52:55], v[20:23]
    s_waitcnt lgkmcnt(1)
    v_mfma_f32_16x16x32_bf16 v[60:63], v[16:19], v[44:47], v[60:63]
    v_mfma_f32_16x16x32_bf16 v[20:23], v[40:43], v[28:31], v[20:23]
    s_mov_b32 s25, 30000
    s_waitcnt lgkmcnt(0)
    v_mfma_f32_16x16x32_bf16 v[20:23], v[24:27], v[44:47], v[20:23]
    ds_read_b32 v11, v15 offset:32544
    ds_read_b128 v[32:35], v9 offset:0
    ds_read_b128 v[36:39], v9 offset:64
    ds_read_b128 v[40:43], v9 offset:128
    ds_read_b128 v[16:19], v9 offset:192
    s_waitcnt lgkmcnt(4)
    v_cmp_gt_u32 vcc, s61, v11
    s_cbranch_vccz fwk_ok_99
fwk_98:
    ds_read_b32 v11, v15 offset:32544
    s_sub_u32 s25, s25, 1
    s_cbranch_scc1 L_err
    s_waitcnt lgkmcnt(0)
    v_cmp_gt_u32 vcc, s61, v11
    s_cbranch_vccnz fwk_98
    ds_read_b128 v[32:35], v9 offset:0
    ds_read_b128 v[36:39], v9 offset:64
    ds_read_b128 v[40:43], v9 offset:128
    ds_read_b128 v[16:19], v9 offset:192
fwk_ok_99:
    v_add_f32 v56, v56, v57
    v_add_f32 v58, v58, v59
    s_waitcnt lgkmcnt(3)
    v_mfma_f32_16x16x32_bf16 v[24:27], v[32:35], v[48:51], 0
    v_cvt_pk_bf16_f32 v56, v56, v58
    v_mov_b32 v57, 0
    s_waitcnt lgkmcnt(2)
    v_mfma_f32_16x16x32_bf16 v[24:27], v[36:39], v[52:55], v[24:27]
    v_max3_f32 v11, v60, v61, v62
    v_max3_f32 v58, v20, v21, v22
    s_waitcnt lgkmcnt(1)
    v_mfma_f32_16x16x32_bf16 v[24:27], v[40:43], v[28:31], v[24:27]
    v_max3_f32 v11, v11, v63, v23
    s_waitcnt lgkmcnt(0)
    v_mfma_f32_16x16x32_bf16 v[24:27], v[16:19], v[44:47], v[24:27]
    global_store_dword v6, v56, s[40:41] sc1
    s_add_u32 s40, s40, 65536
    s_addc_u32 s41, s41, 0
    s_cmp_eq_u32 s20, 63
    s_cbranch_scc1 L_rec_done
    s_lshl_b32 s21, s19, 11
    v_add_u32 v59, s21, v1
    ds_read_b128 v[32:35], v59 offset:16384
    ds_read_b128 v[36:39], v59 offset:17408
    v_lshrrev_b32 v17, 2, v1
    s_lshl_b32 s21, s19, 8
    v_add_u32 v17, s21, v17
    v_max3_f32 v11, v11, v58, v24
    v_max_f32 v11, v11, v25
    v_mov_b32 v58, v11
    s_nop 1
    v_permlane32_swap_b32 v11, v58
    v_max_f32 v11, v11, v58
    v_mov_b32 v58, v11
    s_nop 1
    v_permlane16_swap_b32 v11, v58
    v_max_f32 v11, v11, v58
    v_mul_f32 v11, s46, v11
    v_fma_f32 v60, v60, s46, -v11
    v_exp_f32 v60, v60
    v_fma_f32 v61, v61, s46, -v11
    v_exp_f32 v61, v61
    v_fma_f32 v62, v62, s46, -v11
    v_exp_f32 v62, v62
    v_fma_f32 v63, v63, s46, -v11
    v_exp_f32 v63, v63
    v_fma_f32 v20, v20, s46, -v11
    v_exp_f32 v20, v20
    v_fma_f32 v21, v21, s46, -v11
    v_exp_f32 v21, v21
    v_fma_f32 v22, v22, s46, -v11
    v_exp_f32 v22, v22
    v_fma_f32 v23, v23, s46, -v11
    v_exp_f32 v23, v23
    v_cvt_pk_bf16_f32 v60, v60, v61
    v_cvt_pk_bf16_f32 v61, v62, v63
    v_cvt_pk_bf16_f32 v62, v20, v21
    v_cvt_pk_bf16_f32 v63, v22, v23
    v_mov_b32 v44, 0x3f803f80
    v_mov_b32 v45, 0x3f803f80
    v_mov_b64 v[46:47], v[44:45]
    s_mov_b32 s25, 30000
    ds_read_b32 v16, v7 offset:32560
    ds_read_b32 v40, v17 offset:31488
    s_waitcnt lgkmcnt(2)
    v_mfma_f32_16x16x32_bf16 v[28:31], v[44:47], v[60:63], 0
    v_fma_f32 v58, v24, s46, -v11
    v_fma_f32 v59, v25, s46, -v11
    v_mfma_f32_16x16x32_bf16 v[48:51], v[32:35], v[60:63], 0
    v_exp_f32 v58, v58
    v_exp_f32 v59, v59
    v_mfma_f32_16x16x32_bf16 v[52:55], v[36:39], v[60:63], 0
    v_mov_b32 v27, 0
    v_cvt_pk_bf16_f32 v26, v58, v59
    v_mov_b32 v41, 0
    s_branch fwv_in_101
fwv_100:
    ds_read_b32 v16, v7 offset:32560
    ds_read_b32 v40, v17 offset:31488
    s_sub_u32 s25, s25, 1
    s_cbranch_scc1 L_err
fwv_in_101:
    s_waitcnt lgkmcnt(0)
    v_cmp_gt_u32 vcc, s61, v16
    s_cbranch_vccnz fwv_100
    v_mfma_f32_16x16x16_bf16 v[28:31], v[44:45], v[26:27], v[28:31]
    v_mfma_f32_16x16x16_bf16 v[48:51], v[56:57], v[26:27], v[48:51]
    v_mfma_f32_16x16x16_bf16 v[52:55], v[40:41], v[26:27], v[52:55]
    ds_read_b128 v[16:19], v5 offset:0
    ds_read_b128 v[20:23], v5 offset:1024
    ds_read_b128 v[32:35], v5 offset:2048
    ds_read_b128 v[36:39], v5 offset:3072
    s_nop 1
    v_rcp_f32 v58, v28
    s_nop 0
    v_mul_f32 v48, v48, v58
    v_mul_f32 v49, v49, v58
    v_cvt_pk_bf16_f32 v60, v48, v49
    v_mul_f32 v50, v50, v58
    v_mul_f32 v51, v51, v58
    v_cvt_pk_bf16_f32 v61, v50, v51
    v_mul_f32 v52, v52, v58
    v_mul_f32 v53, v53, v58
    v_cvt_pk_bf16_f32 v62, v52, v53
    v_mul_f32 v54, v54, v58
    v_mul_f32 v55, v55, v58
    v_cvt_pk_bf16_f32 v63, v54, v55
    ds_write_b128 v10, v[60:63]
    ds_read_b128 v[40:43], v5 offset:4096
    ds_read_b128 v[44:47], v5 offset:5120
    v_mov_b64 v[48:49], 0
    v_mov_b64 v[50:51], 0
    v_mov_b64 v[52:53], 0
    v_mov_b64 v[54:55], 0
    v_mov_b64 v[56:57], 0
    v_mov_b64 v[58:59], 0
    s_waitcnt lgkmcnt(2)
    s_barrier
    v_mov_b64 v[60:61], 0
    v_mov_b64 v[62:63], 0
    ds_read_b128 v[24:27], v3
    ds_read_b128 v[28:31], v3 offset:128
    s_waitcnt lgkmcnt(1)
    v_smfmac_f32_16x16x64_bf16 v[48:51], v[24:27], v[16:23], v0
    ds_read_b128 v[16:19], v5 offset:6144
    ds_read_b128 v[20:23], v5 offset:7168
    v_smfmac_f32_16x16x64_bf16 v[52:55], v[24:27], v[32:39], v0
    ds_read_b128 v[32:35], v5 offset:16384
    ds_read_b128 v[36:39], v5 offset:17408
    v_smfmac_f32_16x16x64_bf16 v[56:59], v[24:27], v[40:47], v0
    ds_read_b128 v[40:43], v5 offset:18432
    ds_read_b128 v[44:47], v5 offset:19456
    s_waitcnt lgkmcnt(4)
    v_smfmac_f32_16x16x64_bf16 v[60:63], v[24:27], v[16:23], v0
    ds_read_b128 v[16:19], v5 offset:20480
    ds_read_b128 v[20:23], v5 offset:21504
    s_waitcnt lgkmcnt(4)
    v_smfmac_f32_16x16x64_bf16 v[48:51], v[28:31], v[32:39], v0
    ds_read_b128 v[32:35], v5 offset:22528
    ds_read_b128 v[36:39], v5 offset:23552
    s_waitcnt lgkmcnt(4)
    v_smfmac_f32_16x16x64_bf16 v[52:55], v[28:31], v[40:47], v0
    s_waitcnt lgkmcnt(2)
    v_smfmac_f32_16x16x64_bf16 v[56:59], v[28:31], v[16:23], v0
    s_waitcnt lgkmcnt(0)
    v_smfmac_f32_16x16x64_bf16 v[60:63], v[28:31], v[32:39], v0
    v_add_f32 v48, v48, v49
    v_add_f32 v50, v50, v51
    s_nop 1
    v_add_f32 v52, v52, v53
    v_add_f32 v54, v54, v55
    v_add_f32 v56, v56, v57
    v_add_f32 v58, v58, v59
    v_add_f32 v60, v60, v61
    v_add_f32 v62, v62, v63
    v_cvt_pk_bf16_f32 v48, v48, v52
    v_cvt_pk_bf16_f32 v49, v56, v60
    v_cvt_pk_bf16_f32 v50, v50, v54
    v_cvt_pk_bf16_f32 v51, v58, v62
    v_bfi_b32 v48, 1, s3, v48
    v_bfi_b32 v49, 1, s3, v49
    v_bfi_b32 v50, 1, s3, v50
    v_bfi_b32 v51, 1, s3, v51
    global_store_dwordx4 v4, v[48:51], s[30:31] sc1
    s_add_u32 s20, s20, 1
    s_nop 3
    s_branch A_loop_94
L_roleB_s:
    s_lshl_b32 s21, s19, 11
    s_add_u32 m0, s21, 8192
    s_nop 0
    global_load_lds_dwordx4 v1, s[34:35]
    global_load_lds_dwordx4 v1, s[34:35] offset:1024
    s_add_u32 m0, s21, 16384
    s_nop 0
    global_load_lds_dwordx4 v1, s[36:37]
    global_load_lds_dwordx4 v1, s[36:37] offset:1024
    s_add_u32 s34, s34, 262144
    s_addc_u32 s35, s35, 0
    s_add_u32 s36, s36, 262144
    s_addc_u32 s37, s37, 0
    v_mov_b32 v14, 0
    s_setprio 0
    s_mov_b64 s[54:55], s[32:33]
    s_mov_b64 s[56:57], s[42:43]
    s_and_b32 s21, s20, 3
    s_lshl_b32 s21, s21, 13
    s_add_u32 s42, s50, s21
    s_addc_u32 s43, s51, 0
    s_lshl_b32 s24, s19, 10
    s_add_u32 s24, s24, 2048
    s_add_u32 s26, s42, s24
    s_addc_u32 s27, s43, 0
    s_add_u32 s61, s20, 1
    s_bfe_u32 s3, s20, 0x10002
    s_and_b32 s21, s61, 3
    s_lshl_b32 s21, s21, 13
    s_add_u32 s28, s50, s21
    s_addc_u32 s29, s51, 0
    s_and_b32 s21, s20, 3
    s_lshl_b32 s21, s21, 18
    s_add_u32 s30, s52, s21
    s_addc_u32 s31, s53, 0
    s_lshl_b32 s21, s18, 13
    s_add_u32 s21, s21, 2048
    s_add_u32 s32, s30, s21
    s_addc_u32 s33, s31, 0
B_loop_102:
    s_barrier
    global_load_dwordx4 v[56:59], v1, s[26:27] offset:2048 sc1
    ds_read_b128 v[36:39], v5 offset:16384
    ds_read_b128 v[40:43], v5 offset:17408
    v_xor_b32 v60, 1024, v8
    v_xor_b32 v61, 2048, v8
    v_xor_b32 v62, 3072, v8
    v_mov_b64 v[16:17], 0
    v_mov_b64 v[18:19], 0
    v_mov_b64 v[20:21], 0
    v_mov_b64 v[22:23], 0
    v_mov_b64 v[24:25], 0
    v_mov_b64 v[26:27], 0
    v_mov_b32 v13, s61
    s_mov_b32 s25, 30000
p_loop_104:
    global_load_dwordx4 v[56:59], v1, s[26:27] offset:2048 sc1
    s_sub_u32 s25, s25, 1
    s_cbranch_scc1 L_err
    s_waitcnt vmcnt(1)
    v_max3_u32 v11, v56, v57, v58
    v_max_u32 v11, v11, v59
    v_cmp_eq_u32 vcc, -1, v11
    s_nop 0
    s_and_b64 exec, exec, vcc
    s_cbranch_execnz p_loop_104
    s_mov_b64 exec, -1
p_ok_103:
    s_setprio 1
    ds_write_b128 v8, v[56:59] offset:4096
    v_smfmac_f32_16x16x64_bf16 v[16:19], v[56:59], a[32:39], v0
    v_smfmac_f32_16x16x64_bf16 v[20:23], v[56:59], a[96:103], v0
    s_waitcnt lgkmcnt(0)
    s_barrier
    v_smfmac_f32_16x16x64_bf16 v[24:27], v[56:59], v[36:43], v0
    ds_read_b128 v[28:31], v8
    ds_read_b128 v[32:35], v60 offset:0
    ds_read_b128 v[36:39], v60 offset:4096
    ds_read_b128 v[40:43], v61 offset:0
    ds_read_b128 v[44:47], v61 offset:4096
    ds_read_b128 v[48:51], v62 offset:0
    ds_read_b128 v[52:55], v62 offset:4096
    s_waitcnt lgkmcnt(6)
    v_smfmac_f32_16x16x64_bf16 v[16:19], v[28:31], a[0:7], v0
    v_smfmac_f32_16x16x64_bf16 v[20:23], v[28:31], a[64:71], v0
    s_waitcnt lgkmcnt(5)
    v_smfmac_f32_16x16x64_bf16 v[16:19], v[32:35], a[8:15], v0
    v_smfmac_f32_16x16x64_bf16 v[20:23], v[32:35], a[72:79], v0
    s_waitcnt lgkmcnt(4)
    v_smfmac_f32_16x16x64_bf16 v[16:19], v[36:39], a[40:47], v0
    v_smfmac_f32_16x16x64_bf16 v[20:23], v[36:39], a[104:111], v0
    s_waitcnt vmcnt(0)
    ds_read_b128 v[56:59], v5 offset:0
    ds_read_b128 v[60:63], v5 offset:1024
    s_waitcnt lgkmcnt(5)
    v_smfmac_f32_16x16x64_bf16 v[16:19], v[40:43], a[16:23], v0
    v_smfmac_f32_16x16x64_bf16 v[20:23], v[40:43], a[80:87], v0
    s_waitcnt lgkmcnt(4)
    v_smfmac_f32_16x16x64_bf16 v[16:19], v[44:47], a[48:55], v0
    v_smfmac_f32_16x16x64_bf16 v[20:23], v[44:47], a[112:119], v0
    s_waitcnt lgkmcnt(3)
    v_smfmac_f32_16x16x64_bf16 v[16:19], v[48:51], a[24:31], v0
    v_smfmac_f32_16x16x64_bf16 v[20:23], v[48:51], a[88:95], v0
    s_waitcnt lgkmcnt(2)
    v_smfmac_f32_16x16x64_bf16 v[16:19], v[52:55], a[56:63], v0
    v_smfmac_f32_16x16x64_bf16 v[20:23], v[52:55], a[120:127], v0
    s_nop 6
    v_add_f32 v16, v16, v17
    v_add_f32 v18, v18, v19
    v_add_f32 v20, v20, v21
    v_add_f32 v22, v22, v23
    v_cvt_pk_bf16_f32 v11, v16, v20
    v_cvt_pk_bf16_f32 v12, v18, v22
    ds_write2_b32 v2, v11, v12 offset0:0 offset1:72
    ds_write_b32 v7, v13 offset:32544
    s_setprio 0
    ds_read_b128 v[16:19], v5 offset:2048
    ds_read_b128 v[20:23], v5 offset:3072
    s_waitcnt lgkmcnt(4)
    v_smfmac_f32_16x16x64_bf16 v[24:27], v[28:31], v[56:63], v0
    ds_read_b128 v[56:59], v5 offset:18432
    ds_read_b128 v[60:63], v5 offset:19456
    s_waitcnt lgkmcnt(2)
    v_smfmac_f32_16x16x64_bf16 v[24:27], v[32:35], v[16:23], v0
    ds_read_b128 v[16:19], v5 offset:4096
    ds_read_b128 v[20:23], v5 offset:5120
    ds_read_b128 v[28:31], v5 offset:20480
    ds_read_b128 v[32:35], v5 offset:21504
    s_waitcnt lgkmcnt(4)
    v_smfmac_f32_16x16x64_bf16 v[24:27], v[36:39], v[56:63], v0
    ds_read_b128 v[56:59], v5 offset:6144
    ds_read_b128 v[60:63], v5 offset:7168
    s_waitcnt lgkmcnt(4)
    v_smfmac_f32_16x16x64_bf16 v[24:27], v[40:43], v[16:23], v0
    ds_read_b128 v[16:19], v5 offset:22528
    ds_read_b128 v[20:23], v5 offset:23552
    s_waitcnt lgkmcnt(4)
    v_smfmac_f32_16x16x64_bf16 v[24:27], v[44:47], v[28:35], v0
    s_waitcnt lgkmcnt(2)
    v_smfmac_f32_16x16x64_bf16 v[24:27], v[48:51], v[56:63], v0
    v_lshrrev_b32 v12, 2, v8
    s_waitcnt lgkmcnt(0)
    v_smfmac_f32_16x16x64_bf16 v[24:27], v[52:55], v[16:23], v0
    s_nop 7
    v_add_f32 v24, v24, v25
    v_add_f32 v26, v26, v27
    v_cvt_pk_bf16_f32 v11, v24, v26
    ds_write_b32 v12, v11 offset:31488
    ds_write_b32 v7, v13 offset:32560
    s_cmp_lg_u32 s19, 0
    s_cbranch_scc1 nprog_105
    s_lshl_b32 s21, s18, 7
    s_add_u32 s21, s21, 8192
    v_mov_b32 v32, s21
    v_mov_b32 v33, s20
    s_mov_b64 exec, 1
    global_store_dword v32, v33, s[96:97] sc1
    s_mov_b64 exec, -1
nprog_105:
    v_lshrrev_b32 v12, 6, v1
    v_and_b32 v12, 7, v12
    v_mul_u32_u24 v12, 288, v12
    v_and_b32 v32, 0x30, v1
    v_add_u32 v12, v12, v32
    v_lshl_add_u32 v12, v7, 4, v12
    ds_read_b128 v[36:39], v12 offset:26880
    v_mov_b32 v32, v11
    v_mov_b32 v33, v11
    v_mov_b32 v34, v11
    v_mov_b32 v35, v11
    s_nop 0
    v_permlane32_swap_b32 v32, v34
    v_permlane32_swap_b32 v33, v35
    s_nop 1
    v_permlane16_swap_b32 v32, v33
    v_permlane16_swap_b32 v34, v35
    s_mov_b64 exec, 0xffff
    global_store_dwordx4 v6, v[32:35], s[40:41] sc1
    s_mov_b64 exec, -1
    s_add_u32 s40, s40, 65536
    s_addc_u32 s41, s41, 0
    s_waitcnt lgkmcnt(0)
    s_mov_b64 exec, 0xffffffff
    global_store_dwordx4 v10, v[36:39], s[38:39] sc1
    s_mov_b64 exec, -1
    s_add_u32 s38, s38, 65536
    s_addc_u32 s39, s39, 0
    s_cmp_eq_u32 s20, 63
    s_cbranch_scc1 L_rec_done
    s_add_u32 s62, s62, 128
    v_mov_b32 v15, s62
    s_cmp_ge_u32 s20, 62
    s_cbranch_scc1 cntok_106
    s_mov_b32 s25, 8000
cntsp_107:
    v_and_b32 v14, 0xff, v14
    v_cmp_eq_u32 vcc, 4, v14
    s_cbranch_vccnz cntok_106
    global_load_dword v14, v15, s[96:97] offset:128 sc1
    s_sub_u32 s25, s25, 1
    s_cbranch_scc1 L_err
    s_waitcnt vmcnt(0)
    s_branch cntsp_107
cntok_106:
    global_load_dword v14, v15, s[96:97] offset:256 sc1
    s_cmp_eq_u32 s20, 0
    s_cbranch_scc1 norearm_108
    v_mov_b64 v[32:33], -1
    s_mov_b64 exec, s[58:59]
    global_store_dwordx2 v9, v[32:33], s[56:57] sc1
    s_mov_b64 exec, -1
norearm_108:
    v_mov_b64 v[48:49], 0
    v_mov_b64 v[50:51], 0
    v_mov_b64 v[52:53], 0
    v_mov_b64 v[54:55], 0
    v_mov_b64 v[56:57], 0
    v_mov_b64 v[58:59], 0
    v_mov_b64 v[60:61], 0
    v_mov_b64 v[62:63], 0
    s_waitcnt lgkmcnt(0)
    s_barrier
    ds_read_b128 v[16:19], v3
    ds_read_b128 v[20:23], v3 offset:128
    s_lshl_b32 s21, s19, 11
    s_add_u32 m0, s21, 8192
    s_nop 0
    global_load_lds_dwordx4 v1, s[34:35]
    global_load_lds_dwordx4 v1, s[34:35] offset:1024
    s_add_u32 m0, s21, 16384
    s_nop 0
    global_load_lds_dwordx4 v1, s[36:37]
    global_load_lds_dwordx4 v1, s[36:37] offset:1024
    s_add_u32 s34, s34, 262144
    s_addc_u32 s35, s35, 0
    s_add_u32 s36, s36, 262144
    s_addc_u32 s37, s37, 0
    s_setprio 3
    s_waitcnt lgkmcnt(1)
    v_smfmac_f32_16x16x64_bf16 v[48:51], v[16:19], v[64:71], v0
    v_smfmac_f32_16x16x64_bf16 v[52:55], v[16:19], v[72:79], v0
    v_smfmac_f32_16x16x64_bf16 v[56:59], v[16:19], v[80:87], v0
    v_smfmac_f32_16x16x64_bf16 v[60:63], v[16:19], v[88:95], v0
    s_waitcnt lgkmcnt(0)
    v_smfmac_f32_16x16x64_bf16 v[48:51], v[20:23], v[96:103], v0
    v_smfmac_f32_16x16x64_bf16 v[52:55], v[20:23], v[104:111], v0
    v_smfmac_f32_16x16x64_bf16 v[56:59], v[20:23], v[112:119], v0
    v_smfmac_f32_16x16x64_bf16 v[60:63], v[20:23], v[120:127], v0
    s_nop 4
    v_add_f32 v48, v48, v49
    v_add_f32 v50, v50, v51
    v_add_f32 v52, v52, v53
    v_add_f32 v54, v54, v55
    v_add_f32 v56, v56, v57
    v_add_f32 v58, v58, v59
    v_add_f32 v60, v60, v61
    v_add_f32 v62, v62, v63
    v_cvt_pk_bf16_f32 v48, v48, v52
    v_cvt_pk_bf16_f32 v49, v56, v60
    v_cvt_pk_bf16_f32 v50, v50, v54
    v_cvt_pk_bf16_f32 v51, v58, v62
    v_bfi_b32 v48, 1, s3, v48
    v_bfi_b32 v49, 1, s3, v49
    v_bfi_b32 v50, 1, s3, v50
    v_bfi_b32 v51, 1, s3, v51
    global_store_dwordx4 v4, v[48:51], s[30:31] sc1
    s_setprio 0
    v_bfe_u32 v41, v1, 4, 2
    v_bfe_u32 v42, v1, 6, 2
    v_cmp_eq_u32 vcc, 3, v41
    v_mov_b32 v43, 0x3f80
    v_mov_b32 v44, 0x3f800000
    v_cndmask_b32 v43, v43, v44, vcc
    v_cndmask_b32 v41, v41, 0, vcc
    v_or_b32 v41, 12, v41
    v_mul_u32_u24 v40, 0x1111, v41
    v_cmp_eq_u32 vcc, 0, v42
    s_nop 1
    v_cndmask_b32 v36, 0, v43, vcc
    v_cmp_eq_u32 vcc, 1, v42
    s_nop 1
    v_cndmask_b32 v37, 0, v43, vcc
    v_mov_b64 v[38:39], v[36:37]
    v_mov_b64 v[44:45], 0
    v_mov_b64 v[46:47], 0
    s_mov_b64 s[48:49], s[28:29]
    s_mov_b32 s22, s3
    s_add_u32 s20, s20, 1
    s_mov_b64 s[54:55], s[32:33]
    s_mov_b64 s[56:57], s[42:43]
    s_and_b32 s21, s20, 3
    s_lshl_b32 s21, s21, 13
    s_add_u32 s42, s50, s21
    s_addc_u32 s43, s51, 0
    s_lshl_b32 s24, s19, 10
    s_add_u32 s24, s24, 2048
    s_add_u32 s26, s42, s24
    s_addc_u32 s27, s43, 0
    s_add_u32 s61, s20, 1
    s_bfe_u32 s3, s20, 0x10002
    s_and_b32 s21, s61, 3
    s_lshl_b32 s21, s21, 13
    s_add_u32 s28, s50, s21
    s_addc_u32 s29, s51, 0
    s_and_b32 s21, s20, 3
    s_lshl_b32 s21, s21, 18
    s_add_u32 s30, s52, s21
    s_addc_u32 s31, s53, 0
    s_lshl_b32 s21, s18, 13
    s_add_u32 s21, s21, 2048
    s_add_u32 s32, s30, s21
    s_addc_u32 s33, s31, 0
    s_nop 15
    s_nop 15
    s_nop 15
    s_cmp_lg_u32 s22, 0
    s_cbranch_scc1 tag1_109
    s_mov_b32 s25, 30000
    global_load_dwordx4 v[28:31], v8, s[54:55] offset:-2048 sc1
    global_load_dwordx4 v[32:35], v8, s[54:55] offset:2048 sc1
    s_waitcnt vmcnt(0)
    v_bitop3_b32 v11, v28, v29, v30 bitop3:0xfe
    v_bitop3_b32 v12, v32, v33, v34 bitop3:0xfe
    v_bitop3_b32 v11, v11, v31, v35 bitop3:0xfe
    v_bitop3_b32 v11, v11, v12, 1 bitop3:0xa8
    v_cmp_ne_u32 vcc, 0, v11
    s_cbranch_vccz p_ok_111
    s_mov_b64 exec, vcc
    global_load_dwordx4 v[28:31], v8, s[54:55] offset:-2048 sc1
    global_load_dwordx4 v[32:35], v8, s[54:55] offset:2048 sc1
    s_nop 7
    s_nop 7
p_loop_112:
    global_load_dwordx4 v[28:31], v8, s[54:55] offset:-2048 sc1
    global_load_dwordx4 v[32:35], v8, s[54:55] offset:2048 sc1
    s_sub_u32 s25, s25, 1
    s_cbranch_scc1 L_err
    s_waitcnt vmcnt(2)
    v_bitop3_b32 v11, v28, v29, v30 bitop3:0xfe
    v_bitop3_b32 v12, v32, v33, v34 bitop3:0xfe
    v_bitop3_b32 v11, v11, v31, v35 bitop3:0xfe
    v_bitop3_b32 v11, v11, v12, 1 bitop3:0xa8
    v_cmp_ne_u32 vcc, 0, v11
    s_nop 0
    s_and_b64 exec, exec, vcc
    s_cbranch_execnz p_loop_112
    s_mov_b64 exec, -1
p_ok_111:
    s_branch tagd_110
tag1_109:
    s_mov_b32 s25, 30000
    global_load_dwordx4 v[28:31], v8, s[54:55] offset:-2048 sc1
    global_load_dwordx4 v[32:35], v8, s[54:55] offset:2048 sc1
    s_waitcnt vmcnt(0)
    v_bitop3_b32 v11, v28, v29, v30 bitop3:0x80
    v_bitop3_b32 v12, v32, v33, v34 bitop3:0x80
    v_bitop3_b32 v11, v11, v31, v35 bitop3:0x80
    v_bitop3_b32 v11, v11, v12, 1 bitop3:0x80
    v_cmp_ne_u32 vcc, 1, v11
    s_cbranch_vccz p_ok_113
    s_mov_b64 exec, vcc
    global_load_dwordx4 v[28:31], v8, s[54:55] offset:-2048 sc1
    global_load_dwordx4 v[32:35], v8, s[54:55] offset:2048 sc1
    s_nop 7
    s_nop 7
p_loop_114:
    global_load_dwordx4 v[28:31], v8, s[54:55] offset:-2048 sc1
    global_load_dwordx4 v[32:35], v8, s[54:55] offset:2048 sc1
    s_sub_u32 s25, s25, 1
    s_cbranch_scc1 L_err
    s_waitcnt vmcnt(2)
    v_bitop3_b32 v11, v28, v29, v30 bitop3:0x80
    v_bitop3_b32 v12, v32, v33, v34 bitop3:0x80
    v_bitop3_b32 v11, v11, v31, v35 bitop3:0x80
    v_bitop3_b32 v11, v11, v12, 1 bitop3:0x80
    v_cmp_ne_u32 vcc, 1, v11
    s_nop 0
    s_and_b64 exec, exec, vcc
    s_cbranch_execnz p_loop_114
    s_mov_b64 exec, -1
p_ok_113:
tagd_110:
    v_smfmac_f32_16x16x64_bf16 v[44:47], v[36:39], v[28:35], v40
    s_nop 7
    v_add_f32_dpp v44, v44, v44 row_ror:4 row_mask:0xf bank_mask:0xf
    v_add_f32_dpp v45, v45, v45 row_ror:4 row_mask:0xf bank_mask:0xf
    v_add_f32_dpp v46, v46, v46 row_ror:4 row_mask:0xf bank_mask:0xf
    v_add_f32_dpp v47, v47, v47 row_ror:4 row_mask:0xf bank_mask:0xf
    v_add_f32_dpp v44, v44, v44 row_ror:8 row_mask:0xf bank_mask:0xf
    v_add_f32_dpp v45, v45, v45 row_ror:8 row_mask:0xf bank_mask:0xf
    v_add_f32_dpp v46, v46, v46 row_ror:8 row_mask:0xf bank_mask:0xf
    v_add_f32_dpp v47, v47, v47 row_ror:8 row_mask:0xf bank_mask:0xf
    v_cvt_pk_bf16_f32 v44, v44, v45
    v_cvt_pk_bf16_f32 v45, v46, v47
    s_mov_b64 exec, s[58:59]
    global_store_dwordx2 v9, v[44:45], s[48:49] sc1
    s_mov_b64 exec, -1
    s_branch B_loop_102
L_rec_done:
    s_setprio 0
    s_waitcnt vmcnt(0) lgkmcnt(0)
    s_barrier
    s_cmp_lg_u32 s91, 0
    s_cbranch_scc1 fin_115
    s_lshl_b32 s40, s18, 7
    s_add_u32 s40, s40, 8192
    v_mov_b32 v11, s40
    v_mov_b32 v12, 64
    global_store_dword v11, v12, s[96:97] sc1
fin_115:
    v_mbcnt_lo_u32_b32 v0, -1, 0
    v_mbcnt_hi_u32_b32 v0, -1, v0
    s_branch L_g2
L_err:
    s_mov_b64 exec, -1
    v_mov_b32 v11, 40
    v_mov_b32 v12, 1
    global_atomic_add v11, v12, s[92:93] sc1
L_end:
    s_endpgm
L_code_end:
.section .rodata,"a"
.p2align 6
.amdhsa_kernel adaLN_cond__memory_aug_recurrent_mem_tr__mixer_token_mlp__prompt_kernel
  .amdhsa_next_free_vgpr 256
  .amdhsa_next_free_sgpr 102
  .amdhsa_accum_offset 128
  .amdhsa_group_segment_fixed_size 0
  .amdhsa_kernarg_size 136
  .amdhsa_user_sgpr_count 2
  .amdhsa_user_sgpr_kernarg_segment_ptr 1
  .amdhsa_system_sgpr_workgroup_id_x 1
.end_amdhsa_kernel
.text
```
